```python
import torch

def _softmax(x, axis=-1):
    return torch.softmax(x, dim=axis)
def _gelu(x):
    return torch.nn.functional.gelu(x, approximate="tanh")
def _silu(x):
    return torch.nn.functional.silu(x)
def _sigmoid(x):
    return torch.sigmoid(x)
def _layernorm(x, axis=-1, eps=1e-5):
    m = x.mean(dim=axis, keepdim=True)
    v = x.var(dim=axis, keepdim=True, unbiased=False)
    return (x - m) / torch.sqrt(v + eps)
def _scatter_add(tgt, idx, src, axis=0):
    return tgt.clone().index_add_(axis, idx, src)
def _segment_sum(src, seg, n):
    out = torch.zeros((n,) + src.shape[1:], dtype=src.dtype)
    return out.index_add_(0, seg, src)
def _pad(x, pw):
    flat = tuple(v for pair in reversed(pw) for v in pair)
    return torch.nn.functional.pad(x, flat)

kernel_name = 'sequential_preLN__sliding_local_dilated__dense_activation_gelu__prompt'

def setup_inputs():

    _w = (lambda a: (lambda t: t.to(torch.bfloat16) if t.is_floating_point() else t)(torch.as_tensor(a)))
    def _A_setup():
        B, S, D = 1, 2048, 512
        return {
            "x": _w((lambda *s: torch.randn(*s, dtype=torch.bfloat16) * 0.05)(B, S, D)),
            "wqkv": _w((lambda *s: torch.randn(*s, dtype=torch.bfloat16) * 0.05)(D, 3 * D)),
            "wo": _w((lambda *s: torch.randn(*s, dtype=torch.bfloat16) * 0.05)(D, D)),
        }
    _A_in = _A_setup()

    def _B_setup():
        B, S, D, F = 1, 2048, 512, 1792
        return {
            "x": _w((lambda *s: torch.randn(*s, dtype=torch.bfloat16) * 0.05)(B, S, D)),
            "w1": _w((lambda *s: torch.randn(*s, dtype=torch.bfloat16) * 0.8)(D, F) * (D ** -0.5)),
            "b1": _w((lambda *s: torch.randn(*s, dtype=torch.bfloat16) * 0.8)(F) * 0.01),
            "w2": _w((lambda *s: torch.randn(*s, dtype=torch.bfloat16) * 0.8)(F, D) * (F ** -0.5)),
            "b2": _w((lambda *s: torch.randn(*s, dtype=torch.bfloat16) * 0.8)(D) * 0.01),
        }
    _B_in = _B_setup()

    return {
        "A_x": _A_in["x"],
        "A_wqkv": _A_in["wqkv"],
        "A_wo": _A_in["wo"],
        "B_x": _B_in["x"],
        "B_w1": _B_in["w1"],
        "B_b1": _B_in["b1"],
        "B_w2": _B_in["w2"],
        "B_b2": _B_in["b2"],
    }

def reference(A_x, A_wqkv, A_wo, B_x, B_w1, B_b1, B_w2, B_b2):
    def _A_ref(x, wqkv, wo):
        B, S, D = x.shape
        H = 32; Dh = D // H
        W, dil = 8, 2
        qkv = (lambda x, *d: x.permute(*d))((x @ wqkv).reshape(B, S, 3, H, Dh), 2, 0, 3, 1, 4)
        q, k, v = qkv[0], qkv[1], qkv[2]
        scale = Dh ** -0.5
        pos = torch.arange(S)
        off = torch.arange(W) * dil
        idx = pos[:, None] - off[None, :]
        mask = idx >= 0
        idx_c = torch.where(mask, idx, 0).reshape(-1)
        kg = k[:, :, idx_c, :].reshape(B, H, S, W, Dh)
        vg = v[:, :, idx_c, :].reshape(B, H, S, W, Dh)
        logits = torch.einsum("bhsd,bhswd->bhsw", q, kg) * scale
        logits = torch.where(mask[None, None, :, :], logits, -1e9)
        attn = _softmax(logits, axis=-1)
        o = torch.einsum("bhsw,bhswd->bhsd", attn, vg)
        return (lambda x, *d: x.permute(*d))(o, 0, 2, 1, 3).reshape(B, S, D) @ wo

    def _B_ref(x, w1, b1, w2, b2):
        h = torch.einsum("bsd,df->bsf", x, w1) + b1
        h = _gelu(h)
        return torch.einsum("bsf,fd->bsd", h, w2) + b2

    x = A_x
    h = x + _A_ref(_layernorm(x, axis=-1), A_wqkv, A_wo)
    h2 = h + _B_ref(_layernorm(h, axis=-1), B_w1, B_b1, B_w2, B_b2)
    return h2
```

```asm
; @launch grid=(256,1,1) block=(512,1,1) lds=163840
.amdgcn_target "amdgcn-amd-amdhsa--gfx950"
.text
.globl sequential_preLN__sliding_local_dilated__dense_activation_gelu__prompt_kernel
.p2align 8
.type sequential_preLN__sliding_local_dilated__dense_activation_gelu__prompt_kernel,@function
sequential_preLN__sliding_local_dilated__dense_activation_gelu__prompt_kernel:
  s_cmp_ge_u32 s2, 256
  s_cbranch_scc1 L_END
  s_getpc_b64 s[100:101]
L_PC0:
  s_load_dwordx16 s[4:19], s[0:1], 0
  s_load_dwordx4 s[20:23], s[0:1], 64
  s_load_dwordx2 s[24:25], s[0:1], 80
  v_lshrrev_b32 v1, 6, v0
  v_and_b32 v0, 63, v0
  v_readfirstlane_b32 s56, v1
  s_and_b32 s62, s2, 7
  s_lshr_b32 s63, s2, 3
  s_and_b32 s58, s63, 15
  s_lshr_b32 s63, s63, 4
  s_lshl_b32 s57, s62, 1
  s_add_u32 s57, s57, s63
  s_lshr_b32 s63, s58, 3
  s_lshl_b32 s59, s57, 1
  s_add_u32 s59, s59, s63
  s_and_b32 s60, s58, 7
  s_lshr_b32 s88, s2, 3
  v_lshlrev_b32 v1, 4, v0
  s_cmp_lt_u32 s56, 4
  s_cbranch_scc1 L_COMPUTE
L_LOADER:
  s_sub_u32 s61, s56, 4
  v_lshrrev_b32 v2, 3, v0
  v_and_b32 v3, 7, v0
  s_lshr_b32 s62, s61, 1
  s_lshl_b32 s62, s62, 5
  s_and_b32 s63, s61, 1
  s_add_u32 s62, s62, s63
  s_lshl_b32 s63, s59, 6
  s_add_u32 s62, s62, s63
  s_lshl_b32 s67, s62, 10
  v_lshrrev_b32 v16, 1, v2
  v_xor_b32 v16, v16, v3
  v_lshlrev_b32 v16, 4, v16
  v_lshl_add_u32 v4, v2, 11, v16
  v_add_u32 v4, s67, v4
  v_xor_b32 v5, 64, v4
  v_add_u32 v5, 16384, v5
  s_lshl_b32 s62, s61, 2
  v_add_u32 v16, s62, v2
  v_lshrrev_b32 v17, 1, v16
  v_and_b32 v17, 7, v17
  v_xor_b32 v17, v17, v3
  v_lshlrev_b32 v17, 4, v17
  v_lshlrev_b32 v18, 1, v16
  v_subrev_u32 v19, 15, v18
  v_subrev_u32 v18, 32, v18
  v_cmp_gt_u32 vcc, 8, v16
  s_nop 1
  v_cndmask_b32 v18, v18, v19, vcc
  s_lshl_b32 s63, s59, 6
  v_add_u32 v18, s63, v18
  v_lshlrev_b32 v18, 10, v18
  v_add_u32 v6, v18, v17
  v_and_b32 v16, 7, v16
  v_cmp_eq_u32 vcc, 0, v16
  v_mov_b32 v17, 0x80000000
  s_nop 0
  v_cndmask_b32 v6, v6, v17, vcc
  s_lshl_b32 s62, s61, 4
  s_mul_i32 s62, s62, 3072
  s_lshl_b32 s63, s60, 7
  s_add_u32 s62, s62, s63
  v_add_u32 v16, 0, v0
  v_mul_u32_u24 v17, 2731, v16
  v_lshrrev_b32 v17, 16, v17
  v_mul_u32_u24 v18, 24, v17
  v_sub_u32 v18, v16, v18
  v_lshrrev_b32 v19, 3, v18
  v_and_b32 v20, 2, v17
  v_and_b32 v18, 7, v18
  v_xor_b32 v18, v18, v20
  v_lshlrev_b32 v18, 4, v18
  v_lshl_add_u32 v18, v19, 10, v18
  v_mul_u32_u24 v17, 3072, v17
  v_add3_u32 v8, v17, v18, s62
  v_xor_b32 v11, 64, v8
  v_add_u32 v11, 24576, v11
  v_add_u32 v16, 64, v0
  v_mul_u32_u24 v17, 2731, v16
  v_lshrrev_b32 v17, 16, v17
  v_mul_u32_u24 v18, 24, v17
  v_sub_u32 v18, v16, v18
  v_lshrrev_b32 v19, 3, v18
  v_and_b32 v20, 2, v17
  v_and_b32 v18, 7, v18
  v_xor_b32 v18, v18, v20
  v_lshlrev_b32 v18, 4, v18
  v_lshl_add_u32 v18, v19, 10, v18
  v_mul_u32_u24 v17, 3072, v17
  v_add3_u32 v9, v17, v18, s62
  v_xor_b32 v12, 64, v9
  v_add_u32 v12, 24576, v12
  v_add_u32 v16, 128, v0
  v_mul_u32_u24 v17, 2731, v16
  v_lshrrev_b32 v17, 16, v17
  v_mul_u32_u24 v18, 24, v17
  v_sub_u32 v18, v16, v18
  v_lshrrev_b32 v19, 3, v18
  v_and_b32 v20, 2, v17
  v_and_b32 v18, 7, v18
  v_xor_b32 v18, v18, v20
  v_lshlrev_b32 v18, 4, v18
  v_lshl_add_u32 v18, v19, 10, v18
  v_mul_u32_u24 v17, 3072, v17
  v_add3_u32 v10, v17, v18, s62
  v_xor_b32 v13, 64, v10
  v_add_u32 v13, 24576, v13
  s_add_u32 s90, s59, s60
  s_add_u32 s93, s61, 1
  s_lshl_b32 s93, s93, 11
  s_lshl_b32 s94, s61, 9
  s_mul_i32 s95, s61, 6144
  s_add_u32 s95, s95, 10240
  s_waitcnt lgkmcnt(0)
  s_mov_b32 s28, s4
  s_mov_b32 s29, s5
  s_mov_b32 s30, 2097152
  s_mov_b32 s31, 0x20000
  s_mov_b32 s32, s6
  s_mov_b32 s33, s7
  s_mov_b32 s34, 1572864
  s_mov_b32 s35, 0x20000
  s_add_u32 s62, s90, 0
  s_and_b32 s62, s62, 7
  s_lshl_b32 s91, s62, 7
  s_mul_i32 s92, s62, 196608
  s_add_u32 m0, s93, 0
  s_nop 0
  buffer_load_dwordx4 v4, s[28:31], s91 offen lds
  s_add_u32 m0, m0, 1024
  s_nop 0
  buffer_load_dwordx4 v5, s[28:31], s91 offen lds
  s_add_u32 m0, s94, 0
  s_mov_b32 exec_hi, 0
  buffer_load_dwordx4 v6, s[28:31], s91 offen lds
  s_mov_b32 exec_hi, -1
  s_add_u32 m0, s95, 0
  s_nop 0
  buffer_load_dwordx4 v8, s[32:35], s92 offen lds
  s_add_u32 m0, m0, 1024
  s_nop 0
  buffer_load_dwordx4 v9, s[32:35], s92 offen lds
  s_add_u32 m0, m0, 1024
  s_nop 0
  buffer_load_dwordx4 v10, s[32:35], s92 offen lds
  s_add_u32 m0, m0, 1024
  s_nop 0
  buffer_load_dwordx4 v11, s[32:35], s92 offen lds
  s_add_u32 m0, m0, 1024
  s_nop 0
  buffer_load_dwordx4 v12, s[32:35], s92 offen lds
  s_add_u32 m0, m0, 1024
  s_nop 0
  buffer_load_dwordx4 v13, s[32:35], s92 offen lds
  s_add_u32 s62, s90, 1
  s_and_b32 s62, s62, 7
  s_lshl_b32 s91, s62, 7
  s_mul_i32 s92, s62, 196608
  s_add_u32 m0, s93, 34816
  s_nop 0
  buffer_load_dwordx4 v4, s[28:31], s91 offen lds
  s_add_u32 m0, m0, 1024
  s_nop 0
  buffer_load_dwordx4 v5, s[28:31], s91 offen lds
  s_add_u32 m0, s94, 34816
  s_mov_b32 exec_hi, 0
  buffer_load_dwordx4 v6, s[28:31], s91 offen lds
  s_mov_b32 exec_hi, -1
  s_add_u32 m0, s95, 34816
  s_nop 0
  buffer_load_dwordx4 v8, s[32:35], s92 offen lds
  s_add_u32 m0, m0, 1024
  s_nop 0
  buffer_load_dwordx4 v9, s[32:35], s92 offen lds
  s_add_u32 m0, m0, 1024
  s_nop 0
  buffer_load_dwordx4 v10, s[32:35], s92 offen lds
  s_add_u32 m0, m0, 1024
  s_nop 0
  buffer_load_dwordx4 v11, s[32:35], s92 offen lds
  s_add_u32 m0, m0, 1024
  s_nop 0
  buffer_load_dwordx4 v12, s[32:35], s92 offen lds
  s_add_u32 m0, m0, 1024
  s_nop 0
  buffer_load_dwordx4 v13, s[32:35], s92 offen lds
  s_mov_b32 s36, s8
  s_mov_b32 s37, s9
  s_mov_b32 s38, 524288
  s_mov_b32 s39, 0x20000
  s_mov_b32 s40, s12
  s_mov_b32 s41, s13
  s_mov_b32 s42, 1835008
  s_mov_b32 s43, 0x20000
  s_mov_b32 s44, s16
  s_mov_b32 s45, s17
  s_mov_b32 s46, 1835008
  s_mov_b32 s47, 0x20000
  v_lshrrev_b32 v16, 1, v2
  v_and_b32 v16, 1, v16
  v_lshlrev_b32 v16, 2, v16
  v_xor_b32 v16, v16, v3
  v_lshlrev_b32 v16, 4, v16
  v_lshl_add_u32 v14, v2, 10, v16
  s_lshl_b32 s62, s60, 7
  v_add_u32 v14, s62, v14
  v_mul_u32_u24 v15, 3584, v2
  v_add_u32 v15, v15, v16
  s_min_u32 s62, s58, 13
  s_lshl_b32 s62, s62, 8
  v_add_u32 v15, s62, v15
  s_lshr_b32 s62, s61, 1
  s_and_b32 s63, s61, 1
  s_mul_i32 s96, s62, 917504
  s_lshl_b32 s64, s63, 13
  s_add_u32 s96, s96, s64
  s_mul_i32 s97, s62, 14336
  s_lshl_b32 s64, s63, 10
  s_add_u32 s97, s97, s64
  s_mov_b32 s68, 0
  s_mov_b32 s69, 131072
  s_mov_b32 s70, 262144
  s_mov_b32 s71, 393216
  s_mov_b32 s72, 524288
  s_mov_b32 s73, 655360
  s_mov_b32 s74, 786432
  s_add_u32 s68, s68, s96
  s_add_u32 s69, s69, s96
  s_add_u32 s70, s70, s96
  s_add_u32 s71, s71, s96
  s_add_u32 s72, s72, s96
  s_add_u32 s73, s73, s96
  s_add_u32 s74, s74, s96
  s_waitcnt vmcnt(9)
  s_barrier
  s_add_u32 s62, s90, 2
  s_and_b32 s62, s62, 7
  s_lshl_b32 s91, s62, 7
  s_mul_i32 s92, s62, 196608
  s_add_u32 m0, s93, 69632
  s_nop 0
  buffer_load_dwordx4 v4, s[28:31], s91 offen lds
  s_add_u32 m0, m0, 1024
  s_nop 0
  buffer_load_dwordx4 v5, s[28:31], s91 offen lds
  s_add_u32 m0, s94, 69632
  s_mov_b32 exec_hi, 0
  buffer_load_dwordx4 v6, s[28:31], s91 offen lds
  s_mov_b32 exec_hi, -1
  s_add_u32 m0, s95, 69632
  s_nop 0
  buffer_load_dwordx4 v8, s[32:35], s92 offen lds
  s_add_u32 m0, m0, 1024
  s_nop 0
  buffer_load_dwordx4 v9, s[32:35], s92 offen lds
  s_add_u32 m0, m0, 1024
  s_nop 0
  buffer_load_dwordx4 v10, s[32:35], s92 offen lds
  s_add_u32 m0, m0, 1024
  s_nop 0
  buffer_load_dwordx4 v11, s[32:35], s92 offen lds
  s_add_u32 m0, m0, 1024
  s_nop 0
  buffer_load_dwordx4 v12, s[32:35], s92 offen lds
  s_add_u32 m0, m0, 1024
  s_nop 0
  buffer_load_dwordx4 v13, s[32:35], s92 offen lds
  s_waitcnt vmcnt(9)
  s_barrier
  s_add_u32 s62, s90, 3
  s_and_b32 s62, s62, 7
  s_lshl_b32 s91, s62, 7
  s_mul_i32 s92, s62, 196608
  s_add_u32 m0, s93, 104448
  s_nop 0
  buffer_load_dwordx4 v4, s[28:31], s91 offen lds
  s_add_u32 m0, m0, 1024
  s_nop 0
  buffer_load_dwordx4 v5, s[28:31], s91 offen lds
  s_add_u32 m0, s94, 104448
  s_mov_b32 exec_hi, 0
  buffer_load_dwordx4 v6, s[28:31], s91 offen lds
  s_mov_b32 exec_hi, -1
  s_add_u32 m0, s95, 104448
  s_nop 0
  buffer_load_dwordx4 v8, s[32:35], s92 offen lds
  s_add_u32 m0, m0, 1024
  s_nop 0
  buffer_load_dwordx4 v9, s[32:35], s92 offen lds
  s_add_u32 m0, m0, 1024
  s_nop 0
  buffer_load_dwordx4 v10, s[32:35], s92 offen lds
  s_add_u32 m0, m0, 1024
  s_nop 0
  buffer_load_dwordx4 v11, s[32:35], s92 offen lds
  s_add_u32 m0, m0, 1024
  s_nop 0
  buffer_load_dwordx4 v12, s[32:35], s92 offen lds
  s_add_u32 m0, m0, 1024
  s_nop 0
  buffer_load_dwordx4 v13, s[32:35], s92 offen lds
  s_waitcnt vmcnt(9)
  s_barrier
  s_add_u32 s62, s90, 4
  s_and_b32 s62, s62, 7
  s_lshl_b32 s91, s62, 7
  s_mul_i32 s92, s62, 196608
  s_add_u32 m0, s93, 0
  s_nop 0
  buffer_load_dwordx4 v4, s[28:31], s91 offen lds
  s_add_u32 m0, m0, 1024
  s_nop 0
  buffer_load_dwordx4 v5, s[28:31], s91 offen lds
  s_add_u32 m0, s94, 0
  s_mov_b32 exec_hi, 0
  buffer_load_dwordx4 v6, s[28:31], s91 offen lds
  s_mov_b32 exec_hi, -1
  s_add_u32 m0, s95, 0
  s_nop 0
  buffer_load_dwordx4 v8, s[32:35], s92 offen lds
  s_add_u32 m0, m0, 1024
  s_nop 0
  buffer_load_dwordx4 v9, s[32:35], s92 offen lds
  s_add_u32 m0, m0, 1024
  s_nop 0
  buffer_load_dwordx4 v10, s[32:35], s92 offen lds
  s_add_u32 m0, m0, 1024
  s_nop 0
  buffer_load_dwordx4 v11, s[32:35], s92 offen lds
  s_add_u32 m0, m0, 1024
  s_nop 0
  buffer_load_dwordx4 v12, s[32:35], s92 offen lds
  s_add_u32 m0, m0, 1024
  s_nop 0
  buffer_load_dwordx4 v13, s[32:35], s92 offen lds
  s_waitcnt vmcnt(9)
  s_barrier
  s_add_u32 s62, s90, 5
  s_and_b32 s62, s62, 7
  s_lshl_b32 s91, s62, 7
  s_mul_i32 s92, s62, 196608
  s_add_u32 m0, s93, 34816
  s_nop 0
  buffer_load_dwordx4 v4, s[28:31], s91 offen lds
  s_add_u32 m0, m0, 1024
  s_nop 0
  buffer_load_dwordx4 v5, s[28:31], s91 offen lds
  s_add_u32 m0, s94, 34816
  s_mov_b32 exec_hi, 0
  buffer_load_dwordx4 v6, s[28:31], s91 offen lds
  s_mov_b32 exec_hi, -1
  s_add_u32 m0, s95, 34816
  s_nop 0
  buffer_load_dwordx4 v8, s[32:35], s92 offen lds
  s_add_u32 m0, m0, 1024
  s_nop 0
  buffer_load_dwordx4 v9, s[32:35], s92 offen lds
  s_add_u32 m0, m0, 1024
  s_nop 0
  buffer_load_dwordx4 v10, s[32:35], s92 offen lds
  s_add_u32 m0, m0, 1024
  s_nop 0
  buffer_load_dwordx4 v11, s[32:35], s92 offen lds
  s_add_u32 m0, m0, 1024
  s_nop 0
  buffer_load_dwordx4 v12, s[32:35], s92 offen lds
  s_add_u32 m0, m0, 1024
  s_nop 0
  buffer_load_dwordx4 v13, s[32:35], s92 offen lds
  s_waitcnt vmcnt(9)
  s_barrier
  s_add_u32 s62, s90, 6
  s_and_b32 s62, s62, 7
  s_lshl_b32 s91, s62, 7
  s_mul_i32 s92, s62, 196608
  s_add_u32 m0, s93, 69632
  s_nop 0
  buffer_load_dwordx4 v4, s[28:31], s91 offen lds
  s_add_u32 m0, m0, 1024
  s_nop 0
  buffer_load_dwordx4 v5, s[28:31], s91 offen lds
  s_add_u32 m0, s94, 69632
  s_mov_b32 exec_hi, 0
  buffer_load_dwordx4 v6, s[28:31], s91 offen lds
  s_mov_b32 exec_hi, -1
  s_add_u32 m0, s95, 69632
  s_nop 0
  buffer_load_dwordx4 v8, s[32:35], s92 offen lds
  s_add_u32 m0, m0, 1024
  s_nop 0
  buffer_load_dwordx4 v9, s[32:35], s92 offen lds
  s_add_u32 m0, m0, 1024
  s_nop 0
  buffer_load_dwordx4 v10, s[32:35], s92 offen lds
  s_add_u32 m0, m0, 1024
  s_nop 0
  buffer_load_dwordx4 v11, s[32:35], s92 offen lds
  s_add_u32 m0, m0, 1024
  s_nop 0
  buffer_load_dwordx4 v12, s[32:35], s92 offen lds
  s_add_u32 m0, m0, 1024
  s_nop 0
  buffer_load_dwordx4 v13, s[32:35], s92 offen lds
  s_waitcnt vmcnt(9)
  s_barrier
  s_add_u32 s62, s90, 7
  s_and_b32 s62, s62, 7
  s_lshl_b32 s91, s62, 7
  s_mul_i32 s92, s62, 196608
  s_add_u32 m0, s93, 104448
  s_nop 0
  buffer_load_dwordx4 v4, s[28:31], s91 offen lds
  s_add_u32 m0, m0, 1024
  s_nop 0
  buffer_load_dwordx4 v5, s[28:31], s91 offen lds
  s_add_u32 m0, s94, 104448
  s_mov_b32 exec_hi, 0
  buffer_load_dwordx4 v6, s[28:31], s91 offen lds
  s_mov_b32 exec_hi, -1
  s_add_u32 m0, s95, 104448
  s_nop 0
  buffer_load_dwordx4 v8, s[32:35], s92 offen lds
  s_add_u32 m0, m0, 1024
  s_nop 0
  buffer_load_dwordx4 v9, s[32:35], s92 offen lds
  s_add_u32 m0, m0, 1024
  s_nop 0
  buffer_load_dwordx4 v10, s[32:35], s92 offen lds
  s_add_u32 m0, m0, 1024
  s_nop 0
  buffer_load_dwordx4 v11, s[32:35], s92 offen lds
  s_add_u32 m0, m0, 1024
  s_nop 0
  buffer_load_dwordx4 v12, s[32:35], s92 offen lds
  s_add_u32 m0, m0, 1024
  s_nop 0
  buffer_load_dwordx4 v13, s[32:35], s92 offen lds
  s_lshl_b32 s62, s60, 7
  s_lshl_b32 s63, s61, 11
  s_add_u32 m0, s63, 147456
  s_nop 0
  buffer_load_dwordx4 v4, s[28:31], s62 offen lds
  s_add_u32 m0, m0, 1024
  s_nop 0
  buffer_load_dwordx4 v5, s[28:31], s62 offen lds
  s_waitcnt vmcnt(11)
  s_barrier
  s_mul_i32 s63, s61, 16384
  s_add_u32 m0, s63, 0
  s_lshl_b32 s62, s61, 17
  buffer_load_dwordx4 v14, s[36:39], s62 offen lds
  s_add_u32 m0, m0, 1024
  s_add_u32 s62, s62, 8192
  buffer_load_dwordx4 v14, s[36:39], s62 offen lds
  s_add_u32 m0, m0, 1024
  s_add_u32 s62, s62, 8192
  buffer_load_dwordx4 v14, s[36:39], s62 offen lds
  s_add_u32 m0, m0, 1024
  s_add_u32 s62, s62, 8192
  buffer_load_dwordx4 v14, s[36:39], s62 offen lds
  s_add_u32 m0, m0, 1024
  s_add_u32 s62, s62, 8192
  buffer_load_dwordx4 v14, s[36:39], s62 offen lds
  s_add_u32 m0, m0, 1024
  s_add_u32 s62, s62, 8192
  buffer_load_dwordx4 v14, s[36:39], s62 offen lds
  s_add_u32 m0, m0, 1024
  s_add_u32 s62, s62, 8192
  buffer_load_dwordx4 v14, s[36:39], s62 offen lds
  s_add_u32 m0, m0, 1024
  s_add_u32 s62, s62, 8192
  buffer_load_dwordx4 v14, s[36:39], s62 offen lds
  s_waitcnt vmcnt(10)
  s_barrier
  s_mul_i32 s63, s61, 16384
  s_add_u32 m0, s63, 8192
  s_lshl_b32 s62, s61, 17
  s_add_u32 s62, s62, 65536
  buffer_load_dwordx4 v14, s[36:39], s62 offen lds
  s_add_u32 m0, m0, 1024
  s_add_u32 s62, s62, 8192
  buffer_load_dwordx4 v14, s[36:39], s62 offen lds
  s_add_u32 m0, m0, 1024
  s_add_u32 s62, s62, 8192
  buffer_load_dwordx4 v14, s[36:39], s62 offen lds
  s_add_u32 m0, m0, 1024
  s_add_u32 s62, s62, 8192
  buffer_load_dwordx4 v14, s[36:39], s62 offen lds
  s_add_u32 m0, m0, 1024
  s_add_u32 s62, s62, 8192
  buffer_load_dwordx4 v14, s[36:39], s62 offen lds
  s_add_u32 m0, m0, 1024
  s_add_u32 s62, s62, 8192
  buffer_load_dwordx4 v14, s[36:39], s62 offen lds
  s_add_u32 m0, m0, 1024
  s_add_u32 s62, s62, 8192
  buffer_load_dwordx4 v14, s[36:39], s62 offen lds
  s_add_u32 m0, m0, 1024
  s_add_u32 s62, s62, 8192
  buffer_load_dwordx4 v14, s[36:39], s62 offen lds
  s_barrier
  s_mul_i32 s63, s61, 16384
  s_add_u32 m0, s63, 65536
  s_mul_i32 s62, s61, 458752
  buffer_load_dwordx4 v15, s[40:43], s62 offen lds
  s_add_u32 m0, m0, 1024
  s_add_u32 s62, s62, 28672
  buffer_load_dwordx4 v15, s[40:43], s62 offen lds
  s_add_u32 m0, m0, 1024
  s_add_u32 s62, s62, 28672
  buffer_load_dwordx4 v15, s[40:43], s62 offen lds
  s_add_u32 m0, m0, 1024
  s_add_u32 s62, s62, 28672
  buffer_load_dwordx4 v15, s[40:43], s62 offen lds
  s_add_u32 m0, m0, 1024
  s_add_u32 s62, s62, 28672
  buffer_load_dwordx4 v15, s[40:43], s62 offen lds
  s_add_u32 m0, m0, 1024
  s_add_u32 s62, s62, 28672
  buffer_load_dwordx4 v15, s[40:43], s62 offen lds
  s_add_u32 m0, m0, 1024
  s_add_u32 s62, s62, 28672
  buffer_load_dwordx4 v15, s[40:43], s62 offen lds
  s_add_u32 m0, m0, 1024
  s_add_u32 s62, s62, 28672
  buffer_load_dwordx4 v15, s[40:43], s62 offen lds
  s_add_u32 m0, m0, 1024
  s_add_u32 s62, s62, 28672
  buffer_load_dwordx4 v15, s[40:43], s62 offen lds
  s_add_u32 m0, m0, 1024
  s_add_u32 s62, s62, 28672
  buffer_load_dwordx4 v15, s[40:43], s62 offen lds
  s_add_u32 m0, m0, 1024
  s_add_u32 s62, s62, 28672
  buffer_load_dwordx4 v15, s[40:43], s62 offen lds
  s_add_u32 m0, m0, 1024
  s_add_u32 s62, s62, 28672
  buffer_load_dwordx4 v15, s[40:43], s62 offen lds
  s_add_u32 m0, m0, 1024
  s_add_u32 s62, s62, 28672
  buffer_load_dwordx4 v15, s[40:43], s62 offen lds
  s_add_u32 m0, m0, 1024
  s_add_u32 s62, s62, 28672
  buffer_load_dwordx4 v15, s[40:43], s62 offen lds
  s_add_u32 m0, m0, 1024
  s_add_u32 s62, s62, 28672
  buffer_load_dwordx4 v15, s[40:43], s62 offen lds
  s_add_u32 m0, m0, 1024
  s_add_u32 s62, s62, 28672
  buffer_load_dwordx4 v15, s[40:43], s62 offen lds
  s_waitcnt vmcnt(16)
  s_barrier
  s_waitcnt vmcnt(0)
  s_barrier
  s_mul_i32 s63, s61, 16384
  s_add_u32 m0, s63, 0
  s_mul_i32 s62, s61, 458752
  s_add_u32 s62, s62, 128
  buffer_load_dwordx4 v15, s[40:43], s62 offen lds
  s_add_u32 m0, m0, 1024
  s_add_u32 s62, s62, 28672
  buffer_load_dwordx4 v15, s[40:43], s62 offen lds
  s_add_u32 m0, m0, 1024
  s_add_u32 s62, s62, 28672
  buffer_load_dwordx4 v15, s[40:43], s62 offen lds
  s_add_u32 m0, m0, 1024
  s_add_u32 s62, s62, 28672
  buffer_load_dwordx4 v15, s[40:43], s62 offen lds
  s_add_u32 m0, m0, 1024
  s_add_u32 s62, s62, 28672
  buffer_load_dwordx4 v15, s[40:43], s62 offen lds
  s_add_u32 m0, m0, 1024
  s_add_u32 s62, s62, 28672
  buffer_load_dwordx4 v15, s[40:43], s62 offen lds
  s_add_u32 m0, m0, 1024
  s_add_u32 s62, s62, 28672
  buffer_load_dwordx4 v15, s[40:43], s62 offen lds
  s_add_u32 m0, m0, 1024
  s_add_u32 s62, s62, 28672
  buffer_load_dwordx4 v15, s[40:43], s62 offen lds
  s_add_u32 m0, m0, 1024
  s_add_u32 s62, s62, 28672
  buffer_load_dwordx4 v15, s[40:43], s62 offen lds
  s_add_u32 m0, m0, 1024
  s_add_u32 s62, s62, 28672
  buffer_load_dwordx4 v15, s[40:43], s62 offen lds
  s_add_u32 m0, m0, 1024
  s_add_u32 s62, s62, 28672
  buffer_load_dwordx4 v15, s[40:43], s62 offen lds
  s_add_u32 m0, m0, 1024
  s_add_u32 s62, s62, 28672
  buffer_load_dwordx4 v15, s[40:43], s62 offen lds
  s_add_u32 m0, m0, 1024
  s_add_u32 s62, s62, 28672
  buffer_load_dwordx4 v15, s[40:43], s62 offen lds
  s_add_u32 m0, m0, 1024
  s_add_u32 s62, s62, 28672
  buffer_load_dwordx4 v15, s[40:43], s62 offen lds
  s_add_u32 m0, m0, 1024
  s_add_u32 s62, s62, 28672
  buffer_load_dwordx4 v15, s[40:43], s62 offen lds
  s_add_u32 m0, m0, 1024
  s_add_u32 s62, s62, 28672
  buffer_load_dwordx4 v15, s[40:43], s62 offen lds
  s_barrier
  s_waitcnt vmcnt(0)
  s_barrier
  s_barrier
  s_barrier
  s_add_u32 m0, s97, 131072
  s_add_u32 s62, s68, 0
  buffer_load_dwordx4 v14, s[44:47], s62 offen lds
  s_add_u32 m0, s97, 133120
  s_add_u32 s62, s68, 16384
  buffer_load_dwordx4 v14, s[44:47], s62 offen lds
  s_add_u32 m0, s97, 135168
  s_add_u32 s62, s68, 32768
  buffer_load_dwordx4 v14, s[44:47], s62 offen lds
  s_add_u32 m0, s97, 137216
  s_add_u32 s62, s68, 49152
  buffer_load_dwordx4 v14, s[44:47], s62 offen lds
  s_add_u32 m0, s97, 139264
  s_add_u32 s62, s69, 0
  buffer_load_dwordx4 v14, s[44:47], s62 offen lds
  s_add_u32 m0, s97, 141312
  s_add_u32 s62, s69, 16384
  buffer_load_dwordx4 v14, s[44:47], s62 offen lds
  s_add_u32 m0, s97, 143360
  s_add_u32 s62, s69, 32768
  buffer_load_dwordx4 v14, s[44:47], s62 offen lds
  s_add_u32 m0, s97, 65536
  s_add_u32 s62, s69, 49152
  buffer_load_dwordx4 v14, s[44:47], s62 offen lds
  s_add_u32 m0, s97, 67584
  s_add_u32 s62, s70, 0
  buffer_load_dwordx4 v14, s[44:47], s62 offen lds
  s_add_u32 m0, s97, 69632
  s_add_u32 s62, s70, 16384
  buffer_load_dwordx4 v14, s[44:47], s62 offen lds
  s_add_u32 m0, s97, 71680
  s_add_u32 s62, s70, 32768
  buffer_load_dwordx4 v14, s[44:47], s62 offen lds
  s_add_u32 m0, s97, 73728
  s_add_u32 s62, s70, 49152
  buffer_load_dwordx4 v14, s[44:47], s62 offen lds
  s_add_u32 m0, s97, 75776
  s_add_u32 s62, s71, 0
  buffer_load_dwordx4 v14, s[44:47], s62 offen lds
  s_add_u32 m0, s97, 77824
  s_add_u32 s62, s71, 16384
  buffer_load_dwordx4 v14, s[44:47], s62 offen lds
  s_add_u32 m0, s97, 0
  s_add_u32 s62, s71, 32768
  buffer_load_dwordx4 v14, s[44:47], s62 offen lds
  s_add_u32 m0, s97, 2048
  s_add_u32 s62, s71, 49152
  buffer_load_dwordx4 v14, s[44:47], s62 offen lds
  s_add_u32 m0, s97, 4096
  s_add_u32 s62, s72, 0
  buffer_load_dwordx4 v14, s[44:47], s62 offen lds
  s_add_u32 m0, s97, 6144
  s_add_u32 s62, s72, 16384
  buffer_load_dwordx4 v14, s[44:47], s62 offen lds
  s_add_u32 m0, s97, 8192
  s_add_u32 s62, s72, 32768
  buffer_load_dwordx4 v14, s[44:47], s62 offen lds
  s_add_u32 m0, s97, 10240
  s_add_u32 s62, s72, 49152
  buffer_load_dwordx4 v14, s[44:47], s62 offen lds
  s_add_u32 m0, s97, 12288
  s_add_u32 s62, s73, 0
  buffer_load_dwordx4 v14, s[44:47], s62 offen lds
  s_barrier
  s_add_u32 m0, s97, 98304
  s_add_u32 s62, s73, 16384
  buffer_load_dwordx4 v14, s[44:47], s62 offen lds
  s_add_u32 m0, s97, 100352
  s_add_u32 s62, s73, 32768
  buffer_load_dwordx4 v14, s[44:47], s62 offen lds
  s_add_u32 m0, s97, 102400
  s_add_u32 s62, s73, 49152
  buffer_load_dwordx4 v14, s[44:47], s62 offen lds
  s_add_u32 m0, s97, 104448
  s_add_u32 s62, s74, 0
  buffer_load_dwordx4 v14, s[44:47], s62 offen lds
  s_add_u32 m0, s97, 106496
  s_add_u32 s62, s74, 16384
  buffer_load_dwordx4 v14, s[44:47], s62 offen lds
  s_add_u32 m0, s97, 108544
  s_add_u32 s62, s74, 32768
  buffer_load_dwordx4 v14, s[44:47], s62 offen lds
  s_add_u32 m0, s97, 110592
  s_add_u32 s62, s74, 49152
  buffer_load_dwordx4 v14, s[44:47], s62 offen lds
  s_add_u32 m0, s97, 32768
  s_add_u32 s62, s68, 65536
  buffer_load_dwordx4 v14, s[44:47], s62 offen lds
  s_add_u32 m0, s97, 34816
  s_add_u32 s62, s68, 81920
  buffer_load_dwordx4 v14, s[44:47], s62 offen lds
  s_add_u32 m0, s97, 36864
  s_add_u32 s62, s68, 98304
  buffer_load_dwordx4 v14, s[44:47], s62 offen lds
  s_add_u32 m0, s97, 38912
  s_add_u32 s62, s68, 114688
  buffer_load_dwordx4 v14, s[44:47], s62 offen lds
  s_add_u32 m0, s97, 40960
  s_add_u32 s62, s69, 65536
  buffer_load_dwordx4 v14, s[44:47], s62 offen lds
  s_add_u32 m0, s97, 43008
  s_add_u32 s62, s69, 81920
  buffer_load_dwordx4 v14, s[44:47], s62 offen lds
  s_add_u32 m0, s97, 45056
  s_add_u32 s62, s69, 98304
  buffer_load_dwordx4 v14, s[44:47], s62 offen lds
  s_waitcnt vmcnt(21)
  s_barrier
  s_waitcnt vmcnt(0)
  s_barrier
  s_add_u32 m0, s97, 131072
  s_add_u32 s62, s69, 114688
  buffer_load_dwordx4 v14, s[44:47], s62 offen lds
  s_add_u32 m0, s97, 133120
  s_add_u32 s62, s70, 65536
  buffer_load_dwordx4 v14, s[44:47], s62 offen lds
  s_add_u32 m0, s97, 135168
  s_add_u32 s62, s70, 81920
  buffer_load_dwordx4 v14, s[44:47], s62 offen lds
  s_add_u32 m0, s97, 137216
  s_add_u32 s62, s70, 98304
  buffer_load_dwordx4 v14, s[44:47], s62 offen lds
  s_add_u32 m0, s97, 139264
  s_add_u32 s62, s70, 114688
  buffer_load_dwordx4 v14, s[44:47], s62 offen lds
  s_add_u32 m0, s97, 141312
  s_add_u32 s62, s71, 65536
  buffer_load_dwordx4 v14, s[44:47], s62 offen lds
  s_add_u32 m0, s97, 143360
  s_add_u32 s62, s71, 81920
  buffer_load_dwordx4 v14, s[44:47], s62 offen lds
  s_add_u32 m0, s97, 65536
  s_add_u32 s62, s71, 98304
  buffer_load_dwordx4 v14, s[44:47], s62 offen lds
  s_add_u32 m0, s97, 67584
  s_add_u32 s62, s71, 114688
  buffer_load_dwordx4 v14, s[44:47], s62 offen lds
  s_add_u32 m0, s97, 69632
  s_add_u32 s62, s72, 65536
  buffer_load_dwordx4 v14, s[44:47], s62 offen lds
  s_add_u32 m0, s97, 71680
  s_add_u32 s62, s72, 81920
  buffer_load_dwordx4 v14, s[44:47], s62 offen lds
  s_add_u32 m0, s97, 73728
  s_add_u32 s62, s72, 98304
  buffer_load_dwordx4 v14, s[44:47], s62 offen lds
  s_add_u32 m0, s97, 75776
  s_add_u32 s62, s72, 114688
  buffer_load_dwordx4 v14, s[44:47], s62 offen lds
  s_add_u32 m0, s97, 77824
  s_add_u32 s62, s73, 65536
  buffer_load_dwordx4 v14, s[44:47], s62 offen lds
  s_cmp_lg_u32 s61, 0
  s_cbranch_scc1 npoll_1_87c0
  s_lshl_b32 s63, s57, 4
  v_mov_b32 v21, s63
  s_mov_b32 s66, 262144
ml_3_87c0:
  global_load_dword v22, v21, s[22:23] sc1
  s_sub_u32 s66, s66, 1
  s_waitcnt vmcnt(0)
  v_readfirstlane_b32 s62, v22
  s_cmp_eq_u32 s66, 0
  s_cbranch_scc1 mok_2_87c0
  s_and_b32 s63, s62, 0xff
  s_cmp_lt_u32 s63, 16
  s_cbranch_scc1 ml_3_87c0
mok_2_87c0:
  s_bfe_u32 s63, s62, 0x80008
  s_mul_i32 s63, s63, s63
  s_bfe_u32 s62, s62, 0xc0010
  s_lshl_b32 s62, s62, 4
  s_cmp_eq_u32 s62, s63
  s_cselect_b32 s89, 1, 0
  s_add_u32 s90, s57, 64
  s_cmp_eq_u32 s89, 0
  s_cbranch_scc1 pg_4_87c0
  s_lshl_b32 s62, s90, 7
  s_add_u32 s62, s62, 12091392
  v_and_b32 v21, 15, v0
  v_lshl_add_u32 v21, v21, 2, s62
  s_mov_b32 s66, 262144
  s_mov_b64 exec, 0x3fff
pl_6_87c0:
  global_load_dword v22, v21, s[24:25] sc1
  s_sub_u32 s66, s66, 1
  s_waitcnt vmcnt(0)
  v_cmp_ne_u32 vcc, 1, v22
  s_cmp_eq_u32 s66, 0
  s_cbranch_scc1 pl_6_87c0x
  s_nop 3
  s_cbranch_vccnz pl_6_87c0
pl_6_87c0x:
  s_mov_b64 exec, -1
  s_branch pe_5_87c0
pg_4_87c0:
  s_lshl_b32 s62, s90, 8
  s_add_u32 s62, s62, 12058624
  v_mov_b32 v21, s62
  s_mov_b32 s66, 262144
poll_7_87c0:
  global_load_dword v22, v21, s[24:25] sc1
  s_sub_u32 s66, s66, 1
  s_waitcnt vmcnt(0)
  v_readfirstlane_b32 s62, v22
  s_cmp_eq_u32 s66, 0
  s_cbranch_scc1 pdone_8_87c0
  s_cmp_ge_u32 s62, 14
  s_cbranch_scc1 pdone_8_87c0
  s_sleep 1
  s_branch poll_7_87c0
pdone_8_87c0:
pe_5_87c0:
npoll_1_87c0:
  s_barrier
  s_waitcnt vmcnt(0)
  s_barrier
  s_add_u32 m0, s97, 0
  s_add_u32 s62, s73, 81920
  buffer_load_dwordx4 v14, s[44:47], s62 offen lds
  s_add_u32 m0, s97, 2048
  s_add_u32 s62, s73, 98304
  buffer_load_dwordx4 v14, s[44:47], s62 offen lds
  s_add_u32 m0, s97, 4096
  s_add_u32 s62, s73, 114688
  buffer_load_dwordx4 v14, s[44:47], s62 offen lds
  s_add_u32 m0, s97, 6144
  s_add_u32 s62, s74, 65536
  buffer_load_dwordx4 v14, s[44:47], s62 offen lds
  s_add_u32 m0, s97, 8192
  s_add_u32 s62, s74, 81920
  buffer_load_dwordx4 v14, s[44:47], s62 offen lds
  s_add_u32 m0, s97, 10240
  s_add_u32 s62, s74, 98304
  buffer_load_dwordx4 v14, s[44:47], s62 offen lds
  s_add_u32 m0, s97, 12288
  s_add_u32 s62, s74, 114688
  buffer_load_dwordx4 v14, s[44:47], s62 offen lds
  s_waitcnt vmcnt(0)
  s_barrier
  s_barrier
  s_barrier
  s_branch L_END
L_COMPUTE:
  s_setprio 1
  v_and_b32 v2, 15, v0
  v_lshrrev_b32 v3, 4, v0
  v_lshrrev_b32 v9, 1, v2
  v_and_b32 v9, 7, v9
  v_xor_b32 v9, v9, v3
  v_lshlrev_b32 v9, 4, v9
  v_lshl_add_u32 v4, v2, 7, v9
  v_xor_b32 v5, 64, v4
  s_add_u32 s62, s56, 1
  s_lshl_b32 s62, s62, 11
  v_add_u32 v6, s62, v4
  v_add_u32 v7, s62, v5
  v_lshrrev_b32 v9, 2, v2
  v_lshl_add_u32 v10, v3, 3, v9
  v_mul_u32_u24 v10, 384, v10
  v_lshrrev_b32 v9, 1, v9
  v_and_b32 v191, 1, v3
  v_lshl_or_b32 v9, v191, 1, v9
  v_xor_b32 v9, s56, v9
  v_lshl_add_u32 v10, v9, 5, v10
  v_and_b32 v9, 3, v0
  v_lshl_add_u32 v10, v9, 3, v10
  v_add_u32 v8, 10240, v10
  v_mov_b32 v12, 0x3f803f80
  v_mov_b32 v13, 0x3f803f80
  v_mov_b32 v14, 0x3f803f80
  v_mov_b32 v15, 0x3f803f80
  s_cmp_lg_u32 s56, 0
  s_cbranch_scc1 noinit_9_87c0
  v_mov_b32 v9, 161792
  v_mov_b32 v16, 0
  v_mov_b32 v17, 0
  v_mov_b32 v18, 0
  v_mov_b32 v19, 0
  ds_write_b128 v9, v[16:19]
  ds_write_b128 v9, v[16:19] offset:16
  v_lshlrev_b32 v10, 3, v0
  v_add_u32 v10, 160768, v10
  ds_write_b64 v10, v[16:17]
  s_waitcnt lgkmcnt(0)
  s_cmp_lg_u32 s58, 0
  s_cbranch_scc1 nolead_10_87c0
  s_lshl_b32 s62, s57, 1
  v_add_u32 v9, s62, v0
  s_add_u32 s62, s57, 0
  v_lshlrev_b32 v10, 4, v0
  v_add_u32 v10, s62, v10
  v_cmp_lt_u32 vcc, 1, v0
  s_nop 1
  v_cndmask_b32 v9, v9, v10, vcc
  v_lshlrev_b32 v9, 8, v9
  v_add_u32 v9, 12058624, v9
  s_waitcnt lgkmcnt(0)
  s_mov_b64 exec, 31
  global_store_dword v9, v16, s[24:25] sc1
  s_mov_b64 exec, -1
  v_lshrrev_b32 v10, 4, v0
  s_lshl_b32 s62, s57, 1
  v_add_u32 v9, s62, v10
  v_lshlrev_b32 v17, 4, v10
  v_add_u32 v17, s57, v17
  v_cmp_lt_u32 vcc, 1, v10
  s_nop 1
  v_cndmask_b32 v9, v9, v17, vcc
  v_lshlrev_b32 v9, 7, v9
  v_and_b32 v17, 15, v0
  v_lshl_add_u32 v9, v17, 2, v9
  v_add_u32 v9, 12091392, v9
  global_store_dword v9, v16, s[24:25] sc1
  s_add_u32 s62, s57, 64
  s_lshl_b32 s62, s62, 7
  s_add_u32 s62, s62, 12091392
  v_lshl_add_u32 v9, v17, 2, s62
  s_mov_b64 exec, 0xffff
  global_store_dword v9, v16, s[24:25] sc1
  s_mov_b64 exec, -1
  s_waitcnt vmcnt(0)
nolead_10_87c0:
  s_getreg_b32 s62, hwreg(HW_REG_XCC_ID, 0, 4)
  s_mul_i32 s63, s62, s62
  s_lshl_b32 s63, s63, 16
  s_lshl_b32 s62, s62, 8
  s_add_u32 s62, s62, s63
  s_add_u32 s62, s62, 1
  s_lshl_b32 s63, s57, 4
  s_mov_b64 exec, 1
  v_mov_b32 v9, s63
  v_mov_b32 v10, s62
  s_waitcnt lgkmcnt(0)
  global_atomic_add v9, v10, s[22:23]
  s_mov_b64 exec, -1
noinit_9_87c0:
  v_mov_b32 v9, 0xf149f2ca
  v_mov_b32 v10, 0
  v_lshlrev_b32 v191, 2, v3
  s_cmp_eq_u32 s59, 0
  s_cselect_b64 s[64:65], -1, 0
  v_add_u32 v16, 0, v191
  v_sub_u32 v17, v2, v16
  v_cmp_gt_u32 vcc, 8, v17
  s_nop 1
  v_cndmask_b32 v172, v9, v10, vcc
  v_cndmask_b32 v20, 0, -1, vcc
  v_sub_u32 v17, v16, v2
  v_cmp_le_i32 vcc, 9, v17
  s_nop 1
  v_cndmask_b32 v176, v9, v10, vcc
  v_cndmask_b32 v180, v176, v9, s[64:65]
  v_cmp_le_i32 vcc, 1, v17
  s_nop 1
  v_cndmask_b32 v18, v9, v10, vcc
  v_cmp_gt_u32 vcc, 8, v16
  s_nop 1
  v_cndmask_b32 v18, v9, v18, vcc
  v_cndmask_b32 v184, v18, v9, s[64:65]
  v_add_u32 v16, 1, v191
  v_sub_u32 v17, v2, v16
  v_cmp_gt_u32 vcc, 8, v17
  s_nop 1
  v_cndmask_b32 v173, v9, v10, vcc
  v_cndmask_b32 v21, 0, -1, vcc
  v_sub_u32 v17, v16, v2
  v_cmp_le_i32 vcc, 9, v17
  s_nop 1
  v_cndmask_b32 v177, v9, v10, vcc
  v_cndmask_b32 v181, v177, v9, s[64:65]
  v_cmp_le_i32 vcc, 1, v17
  s_nop 1
  v_cndmask_b32 v18, v9, v10, vcc
  v_cmp_gt_u32 vcc, 8, v16
  s_nop 1
  v_cndmask_b32 v18, v9, v18, vcc
  v_cndmask_b32 v185, v18, v9, s[64:65]
  v_add_u32 v16, 2, v191
  v_sub_u32 v17, v2, v16
  v_cmp_gt_u32 vcc, 8, v17
  s_nop 1
  v_cndmask_b32 v174, v9, v10, vcc
  v_cndmask_b32 v22, 0, -1, vcc
  v_sub_u32 v17, v16, v2
  v_cmp_le_i32 vcc, 9, v17
  s_nop 1
  v_cndmask_b32 v178, v9, v10, vcc
  v_cndmask_b32 v182, v178, v9, s[64:65]
  v_cmp_le_i32 vcc, 1, v17
  s_nop 1
  v_cndmask_b32 v18, v9, v10, vcc
  v_cmp_gt_u32 vcc, 8, v16
  s_nop 1
  v_cndmask_b32 v18, v9, v18, vcc
  v_cndmask_b32 v186, v18, v9, s[64:65]
  v_add_u32 v16, 3, v191
  v_sub_u32 v17, v2, v16
  v_cmp_gt_u32 vcc, 8, v17
  s_nop 1
  v_cndmask_b32 v175, v9, v10, vcc
  v_cndmask_b32 v23, 0, -1, vcc
  v_sub_u32 v17, v16, v2
  v_cmp_le_i32 vcc, 9, v17
  s_nop 1
  v_cndmask_b32 v179, v9, v10, vcc
  v_cndmask_b32 v183, v179, v9, s[64:65]
  v_cmp_le_i32 vcc, 1, v17
  s_nop 1
  v_cndmask_b32 v18, v9, v10, vcc
  v_cmp_gt_u32 vcc, 8, v16
  s_nop 1
  v_cndmask_b32 v18, v9, v18, vcc
  v_cndmask_b32 v187, v18, v9, s[64:65]
  v_and_b32 v20, 0xffff, v20
  v_and_b32 v21, 0xffff0000, v21
  v_or_b32 v188, v20, v21
  v_and_b32 v22, 0xffff, v22
  v_and_b32 v23, 0xffff0000, v23
  v_or_b32 v189, v22, v23
  v_and_b32 v9, 3, v2
  v_cmp_eq_u32 s[90:91], 1, v9
  v_cmp_eq_u32 s[92:93], 2, v9
  v_cmp_eq_u32 s[94:95], 3, v9
  v_lshrrev_b32 v9, 2, v2
  v_cmp_eq_u32 s[96:97], v9, v3
  s_waitcnt lgkmcnt(0)
  s_mov_b32 s48, s24
  s_mov_b32 s49, s25
  s_mov_b32 s50, 16777216
  s_mov_b32 s51, 0x20000
  s_mov_b32 s84, 0x00010001
  s_mov_b32 s85, 0x00010001
  s_lshl_b32 s62, s56, 13
  v_lshl_add_u32 v9, v0, 7, s62
  v_min_u32 v10, L_END-L_PC0, v9
  global_load_dword v191, v10, s[100:101]
  v_add_u32 v9, 32768, v9
  v_min_u32 v10, L_END-L_PC0, v9
  s_cmp_lg_u32 s56, 0
  s_cbranch_scc1 L_NOPFC
  global_load_dword v203, v10, s[100:101]
L_NOPFC:
  s_barrier
  ds_read_b64_tr_b16 v[44:45], v8 offset:128
  ds_read_b64_tr_b16 v[46:47], v8 offset:1664
  ds_read_b128 v[20:23], v4 offset:2048
  ds_read_b128 v[24:27], v4 offset:4096
  ds_read_b64_tr_b16 v[48:49], v8 offset:256
  ds_read_b64_tr_b16 v[50:51], v8 offset:1792
  ds_read_b128 v[16:19], v4 offset:0
  ds_read_b64_tr_b16 v[40:41], v8 offset:0
  ds_read_b64_tr_b16 v[42:43], v8 offset:1536
  ds_read_b128 v[28:31], v4 offset:6144
  ds_read_b128 v[32:35], v4 offset:8192
  ds_read_b128 v[36:39], v6
  s_waitcnt lgkmcnt(9)
  v_mfma_f32_16x16x32_bf16 v[108:111], v[44:47], v[20:23], 0
  s_waitcnt lgkmcnt(8)
  v_mfma_f32_16x16x32_bf16 v[112:115], v[44:47], v[24:27], 0
  s_waitcnt lgkmcnt(6)
  v_mfma_f32_16x16x32_bf16 v[128:131], v[20:23], v[48:51], 0
  v_mfma_f32_16x16x32_bf16 v[132:135], v[24:27], v[48:51], 0
  s_waitcnt lgkmcnt(5)
  v_cndmask_b32 v16, v16, v12, s[84:85]
  v_cndmask_b32 v17, v17, v12, s[84:85]
  v_cndmask_b32 v18, v18, v12, s[84:85]
  v_cndmask_b32 v19, v19, v12, s[84:85]
  ds_read_b64_tr_b16 v[80:81], v8 offset:12416
  s_waitcnt lgkmcnt(4)
  v_mfma_f32_16x16x32_bf16 v[88:91], v[40:43], v[20:23], 0
  ds_read_b64_tr_b16 v[82:83], v8 offset:13952
  v_mfma_f32_16x16x32_bf16 v[92:95], v[40:43], v[24:27], 0
  ds_read_b128 v[56:59], v5 offset:2048
  s_waitcnt lgkmcnt(5)
  v_mfma_f32_16x16x32_bf16 v[116:119], v[44:47], v[28:31], 0
  v_mfma_f32_16x16x32_bf16 v[136:139], v[28:31], v[48:51], 0
  ds_read_b128 v[60:63], v5 offset:4096
  v_mfma_f32_16x16x32_bf16 v[96:99], v[40:43], v[28:31], 0
  ds_read_b64_tr_b16 v[84:85], v8 offset:12544
  v_mfma_f32_16x16x32_bf16 v[104:107], v[44:47], v[16:19], 0
  ds_read_b64_tr_b16 v[86:87], v8 offset:14080
  v_mfma_f32_16x16x32_bf16 v[124:127], v[16:19], v[48:51], 0
  v_mfma_f32_16x16x32_bf16 v[144:147], v[40:43], v[16:19], 0
  ds_read_b128 v[52:55], v5 offset:0
  v_mfma_f32_16x16x32_bf16 v[168:171], v[16:19], v[16:19], 0
  ds_read_b64_tr_b16 v[76:77], v8 offset:12288
  s_waitcnt lgkmcnt(9)
  v_mfma_f32_16x16x32_bf16 v[120:123], v[44:47], v[32:35], 0
  ds_read_b64_tr_b16 v[78:79], v8 offset:13824
  v_mfma_f32_16x16x32_bf16 v[140:143], v[32:35], v[48:51], 0
  v_mfma_f32_16x16x32_bf16 v[100:103], v[40:43], v[32:35], 0
  ds_read_b128 v[64:67], v5 offset:6144
  s_waitcnt lgkmcnt(10)
  v_mfma_f32_16x16x32_bf16 v[156:159], v[12:15], v[36:39], 0
  ds_read_b128 v[68:71], v5 offset:8192
  v_mfma_f32_16x16x32_bf16 v[160:163], v[36:39], v[36:39], 0
  ds_read_b128 v[72:75], v7
  s_waitcnt lgkmcnt(9)
  v_mfma_f32_16x16x32_bf16 v[108:111], v[80:83], v[56:59], v[108:111]
  s_waitcnt lgkmcnt(8)
  v_mfma_f32_16x16x32_bf16 v[112:115], v[80:83], v[60:63], v[112:115]
  s_waitcnt lgkmcnt(6)
  v_mfma_f32_16x16x32_bf16 v[128:131], v[56:59], v[84:87], v[128:131]
  v_mfma_f32_16x16x32_bf16 v[132:135], v[60:63], v[84:87], v[132:135]
  s_waitcnt lgkmcnt(5)
  v_cndmask_b32 v52, v52, v12, s[84:85]
  v_cndmask_b32 v53, v53, v12, s[84:85]
  v_cndmask_b32 v54, v54, v12, s[84:85]
  v_cndmask_b32 v55, v55, v12, s[84:85]
  s_waitcnt lgkmcnt(3)
  v_mfma_f32_16x16x32_bf16 v[88:91], v[76:79], v[56:59], v[88:91]
  v_mfma_f32_16x16x32_bf16 v[92:95], v[76:79], v[60:63], v[92:95]
  s_waitcnt lgkmcnt(2)
  v_mfma_f32_16x16x32_bf16 v[116:119], v[80:83], v[64:67], v[116:119]
  v_mfma_f32_16x16x32_bf16 v[136:139], v[64:67], v[84:87], v[136:139]
  v_mfma_f32_16x16x32_bf16 v[96:99], v[76:79], v[64:67], v[96:99]
  v_add_u32 v4, 34816, v4
  v_add_u32 v5, 34816, v5
  v_add_u32 v6, 34816, v6
  v_add_u32 v7, 34816, v7
  v_add_u32 v8, 34816, v8
  s_waitcnt lgkmcnt(0)
  s_barrier
  v_mfma_f32_16x16x32_bf16 v[104:107], v[80:83], v[52:55], v[104:107]
  ds_read_b64_tr_b16 v[44:45], v8 offset:128
  v_mfma_f32_16x16x32_bf16 v[124:127], v[52:55], v[84:87], v[124:127]
  ds_read_b64_tr_b16 v[46:47], v8 offset:1664
  v_mfma_f32_16x16x32_bf16 v[144:147], v[76:79], v[52:55], v[144:147]
  ds_read_b128 v[20:23], v4 offset:2048
  ds_read_b128 v[24:27], v4 offset:4096
  v_mfma_f32_16x16x32_bf16 v[168:171], v[52:55], v[52:55], v[168:171]
  ds_read_b64_tr_b16 v[48:49], v8 offset:256
  v_mfma_f32_16x16x32_bf16 v[120:123], v[80:83], v[68:71], v[120:123]
  ds_read_b64_tr_b16 v[50:51], v8 offset:1792
  v_mfma_f32_16x16x32_bf16 v[140:143], v[68:71], v[84:87], v[140:143]
  ds_read_b128 v[16:19], v4 offset:0
  ds_read_b64_tr_b16 v[40:41], v8 offset:0
  v_mfma_f32_16x16x32_bf16 v[100:103], v[76:79], v[68:71], v[100:103]
  ds_read_b64_tr_b16 v[42:43], v8 offset:1536
  v_mfma_f32_16x16x32_bf16 v[156:159], v[12:15], v[72:75], v[156:159]
  ds_read_b128 v[28:31], v4 offset:6144
  v_mfma_f32_16x16x32_bf16 v[160:163], v[72:75], v[72:75], v[160:163]
  ds_read_b128 v[32:35], v4 offset:8192
  ds_read_b128 v[36:39], v6
  s_waitcnt lgkmcnt(9)
  v_mfma_f32_16x16x32_bf16 v[108:111], v[44:47], v[20:23], v[108:111]
  s_waitcnt lgkmcnt(8)
  v_mfma_f32_16x16x32_bf16 v[112:115], v[44:47], v[24:27], v[112:115]
  s_waitcnt lgkmcnt(6)
  v_mfma_f32_16x16x32_bf16 v[128:131], v[20:23], v[48:51], v[128:131]
  v_mfma_f32_16x16x32_bf16 v[132:135], v[24:27], v[48:51], v[132:135]
  s_waitcnt lgkmcnt(5)
  v_cndmask_b32 v16, v16, v12, s[84:85]
  v_cndmask_b32 v17, v17, v12, s[84:85]
  v_cndmask_b32 v18, v18, v12, s[84:85]
  v_cndmask_b32 v19, v19, v12, s[84:85]
  ds_read_b64_tr_b16 v[80:81], v8 offset:12416
  s_waitcnt lgkmcnt(4)
  v_mfma_f32_16x16x32_bf16 v[88:91], v[40:43], v[20:23], v[88:91]
  ds_read_b64_tr_b16 v[82:83], v8 offset:13952
  v_mfma_f32_16x16x32_bf16 v[92:95], v[40:43], v[24:27], v[92:95]
  ds_read_b128 v[56:59], v5 offset:2048
  s_waitcnt lgkmcnt(5)
  v_mfma_f32_16x16x32_bf16 v[116:119], v[44:47], v[28:31], v[116:119]
  v_mfma_f32_16x16x32_bf16 v[136:139], v[28:31], v[48:51], v[136:139]
  ds_read_b128 v[60:63], v5 offset:4096
  v_mfma_f32_16x16x32_bf16 v[96:99], v[40:43], v[28:31], v[96:99]
  ds_read_b64_tr_b16 v[84:85], v8 offset:12544
  v_mfma_f32_16x16x32_bf16 v[104:107], v[44:47], v[16:19], v[104:107]
  ds_read_b64_tr_b16 v[86:87], v8 offset:14080
  v_mfma_f32_16x16x32_bf16 v[124:127], v[16:19], v[48:51], v[124:127]
  v_mfma_f32_16x16x32_bf16 v[144:147], v[40:43], v[16:19], v[144:147]
  ds_read_b128 v[52:55], v5 offset:0
  v_mfma_f32_16x16x32_bf16 v[168:171], v[16:19], v[16:19], v[168:171]
  ds_read_b64_tr_b16 v[76:77], v8 offset:12288
  s_waitcnt lgkmcnt(9)
  v_mfma_f32_16x16x32_bf16 v[120:123], v[44:47], v[32:35], v[120:123]
  ds_read_b64_tr_b16 v[78:79], v8 offset:13824
  v_mfma_f32_16x16x32_bf16 v[140:143], v[32:35], v[48:51], v[140:143]
  v_mfma_f32_16x16x32_bf16 v[100:103], v[40:43], v[32:35], v[100:103]
  ds_read_b128 v[64:67], v5 offset:6144
  s_waitcnt lgkmcnt(10)
  v_mfma_f32_16x16x32_bf16 v[156:159], v[12:15], v[36:39], v[156:159]
  ds_read_b128 v[68:71], v5 offset:8192
  v_mfma_f32_16x16x32_bf16 v[160:163], v[36:39], v[36:39], v[160:163]
  ds_read_b128 v[72:75], v7
  s_waitcnt lgkmcnt(9)
  v_mfma_f32_16x16x32_bf16 v[108:111], v[80:83], v[56:59], v[108:111]
  s_waitcnt lgkmcnt(8)
  v_mfma_f32_16x16x32_bf16 v[112:115], v[80:83], v[60:63], v[112:115]
  s_waitcnt lgkmcnt(6)
  v_mfma_f32_16x16x32_bf16 v[128:131], v[56:59], v[84:87], v[128:131]
  v_mfma_f32_16x16x32_bf16 v[132:135], v[60:63], v[84:87], v[132:135]
  s_waitcnt lgkmcnt(5)
  v_cndmask_b32 v52, v52, v12, s[84:85]
  v_cndmask_b32 v53, v53, v12, s[84:85]
  v_cndmask_b32 v54, v54, v12, s[84:85]
  v_cndmask_b32 v55, v55, v12, s[84:85]
  s_waitcnt lgkmcnt(3)
  v_mfma_f32_16x16x32_bf16 v[88:91], v[76:79], v[56:59], v[88:91]
  v_mfma_f32_16x16x32_bf16 v[92:95], v[76:79], v[60:63], v[92:95]
  s_waitcnt lgkmcnt(2)
  v_mfma_f32_16x16x32_bf16 v[116:119], v[80:83], v[64:67], v[116:119]
  v_mfma_f32_16x16x32_bf16 v[136:139], v[64:67], v[84:87], v[136:139]
  v_mfma_f32_16x16x32_bf16 v[96:99], v[76:79], v[64:67], v[96:99]
  v_add_u32 v4, 34816, v4
  v_add_u32 v5, 34816, v5
  v_add_u32 v6, 34816, v6
  v_add_u32 v7, 34816, v7
  v_add_u32 v8, 34816, v8
  s_waitcnt lgkmcnt(0)
  s_barrier
  v_mfma_f32_16x16x32_bf16 v[104:107], v[80:83], v[52:55], v[104:107]
  ds_read_b64_tr_b16 v[44:45], v8 offset:128
  v_mfma_f32_16x16x32_bf16 v[124:127], v[52:55], v[84:87], v[124:127]
  ds_read_b64_tr_b16 v[46:47], v8 offset:1664
  v_mfma_f32_16x16x32_bf16 v[144:147], v[76:79], v[52:55], v[144:147]
  ds_read_b128 v[20:23], v4 offset:2048
  ds_read_b128 v[24:27], v4 offset:4096
  v_mfma_f32_16x16x32_bf16 v[168:171], v[52:55], v[52:55], v[168:171]
  ds_read_b64_tr_b16 v[48:49], v8 offset:256
  v_mfma_f32_16x16x32_bf16 v[120:123], v[80:83], v[68:71], v[120:123]
  ds_read_b64_tr_b16 v[50:51], v8 offset:1792
  v_mfma_f32_16x16x32_bf16 v[140:143], v[68:71], v[84:87], v[140:143]
  ds_read_b128 v[16:19], v4 offset:0
  ds_read_b64_tr_b16 v[40:41], v8 offset:0
  v_mfma_f32_16x16x32_bf16 v[100:103], v[76:79], v[68:71], v[100:103]
  ds_read_b64_tr_b16 v[42:43], v8 offset:1536
  v_mfma_f32_16x16x32_bf16 v[156:159], v[12:15], v[72:75], v[156:159]
  ds_read_b128 v[28:31], v4 offset:6144
  v_mfma_f32_16x16x32_bf16 v[160:163], v[72:75], v[72:75], v[160:163]
  ds_read_b128 v[32:35], v4 offset:8192
  ds_read_b128 v[36:39], v6
  s_waitcnt lgkmcnt(9)
  v_mfma_f32_16x16x32_bf16 v[108:111], v[44:47], v[20:23], v[108:111]
  s_waitcnt lgkmcnt(8)
  v_mfma_f32_16x16x32_bf16 v[112:115], v[44:47], v[24:27], v[112:115]
  s_waitcnt lgkmcnt(6)
  v_mfma_f32_16x16x32_bf16 v[128:131], v[20:23], v[48:51], v[128:131]
  v_mfma_f32_16x16x32_bf16 v[132:135], v[24:27], v[48:51], v[132:135]
  s_waitcnt lgkmcnt(5)
  v_cndmask_b32 v16, v16, v12, s[84:85]
  v_cndmask_b32 v17, v17, v12, s[84:85]
  v_cndmask_b32 v18, v18, v12, s[84:85]
  v_cndmask_b32 v19, v19, v12, s[84:85]
  ds_read_b64_tr_b16 v[80:81], v8 offset:12416
  s_waitcnt lgkmcnt(4)
  v_mfma_f32_16x16x32_bf16 v[88:91], v[40:43], v[20:23], v[88:91]
  ds_read_b64_tr_b16 v[82:83], v8 offset:13952
  v_mfma_f32_16x16x32_bf16 v[92:95], v[40:43], v[24:27], v[92:95]
  ds_read_b128 v[56:59], v5 offset:2048
  s_waitcnt lgkmcnt(5)
  v_mfma_f32_16x16x32_bf16 v[116:119], v[44:47], v[28:31], v[116:119]
  v_mfma_f32_16x16x32_bf16 v[136:139], v[28:31], v[48:51], v[136:139]
  ds_read_b128 v[60:63], v5 offset:4096
  v_mfma_f32_16x16x32_bf16 v[96:99], v[40:43], v[28:31], v[96:99]
  ds_read_b64_tr_b16 v[84:85], v8 offset:12544
  v_mfma_f32_16x16x32_bf16 v[104:107], v[44:47], v[16:19], v[104:107]
  ds_read_b64_tr_b16 v[86:87], v8 offset:14080
  v_mfma_f32_16x16x32_bf16 v[124:127], v[16:19], v[48:51], v[124:127]
  v_mfma_f32_16x16x32_bf16 v[144:147], v[40:43], v[16:19], v[144:147]
  ds_read_b128 v[52:55], v5 offset:0
  v_mfma_f32_16x16x32_bf16 v[168:171], v[16:19], v[16:19], v[168:171]
  ds_read_b64_tr_b16 v[76:77], v8 offset:12288
  s_waitcnt lgkmcnt(9)
  v_mfma_f32_16x16x32_bf16 v[120:123], v[44:47], v[32:35], v[120:123]
  ds_read_b64_tr_b16 v[78:79], v8 offset:13824
  v_mfma_f32_16x16x32_bf16 v[140:143], v[32:35], v[48:51], v[140:143]
  v_mfma_f32_16x16x32_bf16 v[100:103], v[40:43], v[32:35], v[100:103]
  ds_read_b128 v[64:67], v5 offset:6144
  s_waitcnt lgkmcnt(10)
  v_mfma_f32_16x16x32_bf16 v[156:159], v[12:15], v[36:39], v[156:159]
  ds_read_b128 v[68:71], v5 offset:8192
  v_mfma_f32_16x16x32_bf16 v[160:163], v[36:39], v[36:39], v[160:163]
  ds_read_b128 v[72:75], v7
  s_waitcnt lgkmcnt(9)
  v_mfma_f32_16x16x32_bf16 v[108:111], v[80:83], v[56:59], v[108:111]
  s_waitcnt lgkmcnt(8)
  v_mfma_f32_16x16x32_bf16 v[112:115], v[80:83], v[60:63], v[112:115]
  s_waitcnt lgkmcnt(6)
  v_mfma_f32_16x16x32_bf16 v[128:131], v[56:59], v[84:87], v[128:131]
  v_mfma_f32_16x16x32_bf16 v[132:135], v[60:63], v[84:87], v[132:135]
  s_waitcnt lgkmcnt(5)
  v_cndmask_b32 v52, v52, v12, s[84:85]
  v_cndmask_b32 v53, v53, v12, s[84:85]
  v_cndmask_b32 v54, v54, v12, s[84:85]
  v_cndmask_b32 v55, v55, v12, s[84:85]
  s_waitcnt lgkmcnt(3)
  v_mfma_f32_16x16x32_bf16 v[88:91], v[76:79], v[56:59], v[88:91]
  v_mfma_f32_16x16x32_bf16 v[92:95], v[76:79], v[60:63], v[92:95]
  s_waitcnt lgkmcnt(2)
  v_mfma_f32_16x16x32_bf16 v[116:119], v[80:83], v[64:67], v[116:119]
  v_mfma_f32_16x16x32_bf16 v[136:139], v[64:67], v[84:87], v[136:139]
  v_mfma_f32_16x16x32_bf16 v[96:99], v[76:79], v[64:67], v[96:99]
  v_add_u32 v4, 34816, v4
  v_add_u32 v5, 34816, v5
  v_add_u32 v6, 34816, v6
  v_add_u32 v7, 34816, v7
  v_add_u32 v8, 34816, v8
  s_waitcnt lgkmcnt(0)
  s_barrier
  s_cmp_ge_u32 s56, 2
  s_cbranch_scc1 npf_11_87c0
  s_mov_b64 s[98:99], s[8:9]
  s_mov_b32 s62, s2
  s_cmp_ge_u32 s2, 32
  s_cselect_b32 s98, s12, s98
  s_cselect_b32 s99, s13, s99
  s_cselect_b32 s63, 32, 0
  s_cmp_ge_u32 s2, 144
  s_cselect_b32 s98, s16, s98
  s_cselect_b32 s99, s17, s99
  s_cselect_b32 s63, 144, s63
  s_sub_u32 s62, s62, s63
  s_lshl_b32 s62, s62, 1
  s_add_u32 s62, s62, s56
  s_lshl_b32 s62, s62, 13
  v_lshl_add_u32 v9, v0, 7, s62
  s_waitcnt vmcnt(0)
  global_load_dword v191, v9, s[98:99]
npf_11_87c0:
  v_mfma_f32_16x16x32_bf16 v[104:107], v[80:83], v[52:55], v[104:107]
  ds_read_b64_tr_b16 v[44:45], v8 offset:128
  v_mfma_f32_16x16x32_bf16 v[124:127], v[52:55], v[84:87], v[124:127]
  ds_read_b64_tr_b16 v[46:47], v8 offset:1664
  v_mfma_f32_16x16x32_bf16 v[144:147], v[76:79], v[52:55], v[144:147]
  ds_read_b128 v[20:23], v4 offset:2048
  ds_read_b128 v[24:27], v4 offset:4096
  v_mfma_f32_16x16x32_bf16 v[168:171], v[52:55], v[52:55], v[168:171]
  ds_read_b64_tr_b16 v[48:49], v8 offset:256
  v_mfma_f32_16x16x32_bf16 v[120:123], v[80:83], v[68:71], v[120:123]
  ds_read_b64_tr_b16 v[50:51], v8 offset:1792
  v_mfma_f32_16x16x32_bf16 v[140:143], v[68:71], v[84:87], v[140:143]
  ds_read_b128 v[16:19], v4 offset:0
  ds_read_b64_tr_b16 v[40:41], v8 offset:0
  v_mfma_f32_16x16x32_bf16 v[100:103], v[76:79], v[68:71], v[100:103]
  ds_read_b64_tr_b16 v[42:43], v8 offset:1536
  v_mfma_f32_16x16x32_bf16 v[156:159], v[12:15], v[72:75], v[156:159]
  ds_read_b128 v[28:31], v4 offset:6144
  v_mfma_f32_16x16x32_bf16 v[160:163], v[72:75], v[72:75], v[160:163]
  ds_read_b128 v[32:35], v4 offset:8192
  ds_read_b128 v[36:39], v6
  s_waitcnt lgkmcnt(9)
  v_mfma_f32_16x16x32_bf16 v[108:111], v[44:47], v[20:23], v[108:111]
  s_waitcnt lgkmcnt(8)
  v_mfma_f32_16x16x32_bf16 v[112:115], v[44:47], v[24:27], v[112:115]
  s_waitcnt lgkmcnt(6)
  v_mfma_f32_16x16x32_bf16 v[128:131], v[20:23], v[48:51], v[128:131]
  v_mfma_f32_16x16x32_bf16 v[132:135], v[24:27], v[48:51], v[132:135]
  s_waitcnt lgkmcnt(5)
  v_cndmask_b32 v16, v16, v12, s[84:85]
  v_cndmask_b32 v17, v17, v12, s[84:85]
  v_cndmask_b32 v18, v18, v12, s[84:85]
  v_cndmask_b32 v19, v19, v12, s[84:85]
  ds_read_b64_tr_b16 v[80:81], v8 offset:12416
  s_waitcnt lgkmcnt(4)
  v_mfma_f32_16x16x32_bf16 v[88:91], v[40:43], v[20:23], v[88:91]
  ds_read_b64_tr_b16 v[82:83], v8 offset:13952
  v_mfma_f32_16x16x32_bf16 v[92:95], v[40:43], v[24:27], v[92:95]
  ds_read_b128 v[56:59], v5 offset:2048
  s_waitcnt lgkmcnt(5)
  v_mfma_f32_16x16x32_bf16 v[116:119], v[44:47], v[28:31], v[116:119]
  v_mfma_f32_16x16x32_bf16 v[136:139], v[28:31], v[48:51], v[136:139]
  ds_read_b128 v[60:63], v5 offset:4096
  v_mfma_f32_16x16x32_bf16 v[96:99], v[40:43], v[28:31], v[96:99]
  ds_read_b64_tr_b16 v[84:85], v8 offset:12544
  v_mfma_f32_16x16x32_bf16 v[104:107], v[44:47], v[16:19], v[104:107]
  ds_read_b64_tr_b16 v[86:87], v8 offset:14080
  v_mfma_f32_16x16x32_bf16 v[124:127], v[16:19], v[48:51], v[124:127]
  v_mfma_f32_16x16x32_bf16 v[144:147], v[40:43], v[16:19], v[144:147]
  ds_read_b128 v[52:55], v5 offset:0
  v_mfma_f32_16x16x32_bf16 v[168:171], v[16:19], v[16:19], v[168:171]
  ds_read_b64_tr_b16 v[76:77], v8 offset:12288
  s_waitcnt lgkmcnt(9)
  v_mfma_f32_16x16x32_bf16 v[120:123], v[44:47], v[32:35], v[120:123]
  ds_read_b64_tr_b16 v[78:79], v8 offset:13824
  v_mfma_f32_16x16x32_bf16 v[140:143], v[32:35], v[48:51], v[140:143]
  v_mfma_f32_16x16x32_bf16 v[100:103], v[40:43], v[32:35], v[100:103]
  ds_read_b128 v[64:67], v5 offset:6144
  s_waitcnt lgkmcnt(10)
  v_mfma_f32_16x16x32_bf16 v[156:159], v[12:15], v[36:39], v[156:159]
  ds_read_b128 v[68:71], v5 offset:8192
  v_mfma_f32_16x16x32_bf16 v[160:163], v[36:39], v[36:39], v[160:163]
  ds_read_b128 v[72:75], v7
  s_waitcnt lgkmcnt(9)
  v_mfma_f32_16x16x32_bf16 v[108:111], v[80:83], v[56:59], v[108:111]
  s_waitcnt lgkmcnt(8)
  v_mfma_f32_16x16x32_bf16 v[112:115], v[80:83], v[60:63], v[112:115]
  s_waitcnt lgkmcnt(6)
  v_mfma_f32_16x16x32_bf16 v[128:131], v[56:59], v[84:87], v[128:131]
  v_mfma_f32_16x16x32_bf16 v[132:135], v[60:63], v[84:87], v[132:135]
  s_waitcnt lgkmcnt(5)
  v_cndmask_b32 v52, v52, v12, s[84:85]
  v_cndmask_b32 v53, v53, v12, s[84:85]
  v_cndmask_b32 v54, v54, v12, s[84:85]
  v_cndmask_b32 v55, v55, v12, s[84:85]
  s_waitcnt lgkmcnt(3)
  v_mfma_f32_16x16x32_bf16 v[88:91], v[76:79], v[56:59], v[88:91]
  v_mfma_f32_16x16x32_bf16 v[92:95], v[76:79], v[60:63], v[92:95]
  s_waitcnt lgkmcnt(2)
  v_mfma_f32_16x16x32_bf16 v[116:119], v[80:83], v[64:67], v[116:119]
  v_mfma_f32_16x16x32_bf16 v[136:139], v[64:67], v[84:87], v[136:139]
  v_mfma_f32_16x16x32_bf16 v[96:99], v[76:79], v[64:67], v[96:99]
  v_add_u32 v4, 4294862848, v4
  v_add_u32 v5, 4294862848, v5
  v_add_u32 v6, 4294862848, v6
  v_add_u32 v7, 4294862848, v7
  v_add_u32 v8, 4294862848, v8
  s_waitcnt lgkmcnt(0)
  s_barrier
  v_mfma_f32_16x16x32_bf16 v[104:107], v[80:83], v[52:55], v[104:107]
  ds_read_b64_tr_b16 v[44:45], v8 offset:128
  v_mfma_f32_16x16x32_bf16 v[124:127], v[52:55], v[84:87], v[124:127]
  ds_read_b64_tr_b16 v[46:47], v8 offset:1664
  v_mfma_f32_16x16x32_bf16 v[144:147], v[76:79], v[52:55], v[144:147]
  ds_read_b128 v[20:23], v4 offset:2048
  ds_read_b128 v[24:27], v4 offset:4096
  v_mfma_f32_16x16x32_bf16 v[168:171], v[52:55], v[52:55], v[168:171]
  ds_read_b64_tr_b16 v[48:49], v8 offset:256
  v_mfma_f32_16x16x32_bf16 v[120:123], v[80:83], v[68:71], v[120:123]
  ds_read_b64_tr_b16 v[50:51], v8 offset:1792
  v_mfma_f32_16x16x32_bf16 v[140:143], v[68:71], v[84:87], v[140:143]
  ds_read_b128 v[16:19], v4 offset:0
  ds_read_b64_tr_b16 v[40:41], v8 offset:0
  v_mfma_f32_16x16x32_bf16 v[100:103], v[76:79], v[68:71], v[100:103]
  ds_read_b64_tr_b16 v[42:43], v8 offset:1536
  v_mfma_f32_16x16x32_bf16 v[156:159], v[12:15], v[72:75], v[156:159]
  ds_read_b128 v[28:31], v4 offset:6144
  v_mfma_f32_16x16x32_bf16 v[160:163], v[72:75], v[72:75], v[160:163]
  ds_read_b128 v[32:35], v4 offset:8192
  ds_read_b128 v[36:39], v6
  s_waitcnt lgkmcnt(9)
  v_mfma_f32_16x16x32_bf16 v[108:111], v[44:47], v[20:23], v[108:111]
  s_waitcnt lgkmcnt(8)
  v_mfma_f32_16x16x32_bf16 v[112:115], v[44:47], v[24:27], v[112:115]
  s_waitcnt lgkmcnt(6)
  v_mfma_f32_16x16x32_bf16 v[128:131], v[20:23], v[48:51], v[128:131]
  v_mfma_f32_16x16x32_bf16 v[132:135], v[24:27], v[48:51], v[132:135]
  s_waitcnt lgkmcnt(5)
  v_cndmask_b32 v16, v16, v12, s[84:85]
  v_cndmask_b32 v17, v17, v12, s[84:85]
  v_cndmask_b32 v18, v18, v12, s[84:85]
  v_cndmask_b32 v19, v19, v12, s[84:85]
  ds_read_b64_tr_b16 v[80:81], v8 offset:12416
  s_waitcnt lgkmcnt(4)
  v_mfma_f32_16x16x32_bf16 v[88:91], v[40:43], v[20:23], v[88:91]
  ds_read_b64_tr_b16 v[82:83], v8 offset:13952
  v_mfma_f32_16x16x32_bf16 v[92:95], v[40:43], v[24:27], v[92:95]
  ds_read_b128 v[56:59], v5 offset:2048
  s_waitcnt lgkmcnt(5)
  v_mfma_f32_16x16x32_bf16 v[116:119], v[44:47], v[28:31], v[116:119]
  v_mfma_f32_16x16x32_bf16 v[136:139], v[28:31], v[48:51], v[136:139]
  ds_read_b128 v[60:63], v5 offset:4096
  v_mfma_f32_16x16x32_bf16 v[96:99], v[40:43], v[28:31], v[96:99]
  ds_read_b64_tr_b16 v[84:85], v8 offset:12544
  v_mfma_f32_16x16x32_bf16 v[104:107], v[44:47], v[16:19], v[104:107]
  ds_read_b64_tr_b16 v[86:87], v8 offset:14080
  v_mfma_f32_16x16x32_bf16 v[124:127], v[16:19], v[48:51], v[124:127]
  v_mfma_f32_16x16x32_bf16 v[144:147], v[40:43], v[16:19], v[144:147]
  ds_read_b128 v[52:55], v5 offset:0
  v_mfma_f32_16x16x32_bf16 v[168:171], v[16:19], v[16:19], v[168:171]
  ds_read_b64_tr_b16 v[76:77], v8 offset:12288
  s_waitcnt lgkmcnt(9)
  v_mfma_f32_16x16x32_bf16 v[120:123], v[44:47], v[32:35], v[120:123]
  ds_read_b64_tr_b16 v[78:79], v8 offset:13824
  v_mfma_f32_16x16x32_bf16 v[140:143], v[32:35], v[48:51], v[140:143]
  v_mfma_f32_16x16x32_bf16 v[100:103], v[40:43], v[32:35], v[100:103]
  ds_read_b128 v[64:67], v5 offset:6144
  s_waitcnt lgkmcnt(10)
  v_mfma_f32_16x16x32_bf16 v[156:159], v[12:15], v[36:39], v[156:159]
  ds_read_b128 v[68:71], v5 offset:8192
  v_mfma_f32_16x16x32_bf16 v[160:163], v[36:39], v[36:39], v[160:163]
  ds_read_b128 v[72:75], v7
  s_waitcnt lgkmcnt(9)
  v_mfma_f32_16x16x32_bf16 v[108:111], v[80:83], v[56:59], v[108:111]
  s_waitcnt lgkmcnt(8)
  v_mfma_f32_16x16x32_bf16 v[112:115], v[80:83], v[60:63], v[112:115]
  s_waitcnt lgkmcnt(6)
  v_mfma_f32_16x16x32_bf16 v[128:131], v[56:59], v[84:87], v[128:131]
  v_mfma_f32_16x16x32_bf16 v[132:135], v[60:63], v[84:87], v[132:135]
  s_waitcnt lgkmcnt(5)
  v_cndmask_b32 v52, v52, v12, s[84:85]
  v_cndmask_b32 v53, v53, v12, s[84:85]
  v_cndmask_b32 v54, v54, v12, s[84:85]
  v_cndmask_b32 v55, v55, v12, s[84:85]
  s_waitcnt lgkmcnt(3)
  v_mfma_f32_16x16x32_bf16 v[88:91], v[76:79], v[56:59], v[88:91]
  v_mfma_f32_16x16x32_bf16 v[92:95], v[76:79], v[60:63], v[92:95]
  s_waitcnt lgkmcnt(2)
  v_mfma_f32_16x16x32_bf16 v[116:119], v[80:83], v[64:67], v[116:119]
  v_mfma_f32_16x16x32_bf16 v[136:139], v[64:67], v[84:87], v[136:139]
  v_mfma_f32_16x16x32_bf16 v[96:99], v[76:79], v[64:67], v[96:99]
  v_add_u32 v4, 34816, v4
  v_add_u32 v5, 34816, v5
  v_add_u32 v6, 34816, v6
  v_add_u32 v7, 34816, v7
  v_add_u32 v8, 34816, v8
  s_waitcnt lgkmcnt(0)
  s_barrier
  v_mfma_f32_16x16x32_bf16 v[104:107], v[80:83], v[52:55], v[104:107]
  ds_read_b64_tr_b16 v[44:45], v8 offset:128
  v_mfma_f32_16x16x32_bf16 v[124:127], v[52:55], v[84:87], v[124:127]
  ds_read_b64_tr_b16 v[46:47], v8 offset:1664
  v_mfma_f32_16x16x32_bf16 v[144:147], v[76:79], v[52:55], v[144:147]
  ds_read_b128 v[20:23], v4 offset:2048
  ds_read_b128 v[24:27], v4 offset:4096
  v_mfma_f32_16x16x32_bf16 v[168:171], v[52:55], v[52:55], v[168:171]
  ds_read_b64_tr_b16 v[48:49], v8 offset:256
  v_mfma_f32_16x16x32_bf16 v[120:123], v[80:83], v[68:71], v[120:123]
  ds_read_b64_tr_b16 v[50:51], v8 offset:1792
  v_mfma_f32_16x16x32_bf16 v[140:143], v[68:71], v[84:87], v[140:143]
  ds_read_b128 v[16:19], v4 offset:0
  ds_read_b64_tr_b16 v[40:41], v8 offset:0
  v_mfma_f32_16x16x32_bf16 v[100:103], v[76:79], v[68:71], v[100:103]
  ds_read_b64_tr_b16 v[42:43], v8 offset:1536
  v_mfma_f32_16x16x32_bf16 v[156:159], v[12:15], v[72:75], v[156:159]
  ds_read_b128 v[28:31], v4 offset:6144
  v_mfma_f32_16x16x32_bf16 v[160:163], v[72:75], v[72:75], v[160:163]
  ds_read_b128 v[32:35], v4 offset:8192
  ds_read_b128 v[36:39], v6
  s_waitcnt lgkmcnt(9)
  v_mfma_f32_16x16x32_bf16 v[108:111], v[44:47], v[20:23], v[108:111]
  s_waitcnt lgkmcnt(8)
  v_mfma_f32_16x16x32_bf16 v[112:115], v[44:47], v[24:27], v[112:115]
  s_waitcnt lgkmcnt(6)
  v_mfma_f32_16x16x32_bf16 v[128:131], v[20:23], v[48:51], v[128:131]
  v_mfma_f32_16x16x32_bf16 v[132:135], v[24:27], v[48:51], v[132:135]
  s_waitcnt lgkmcnt(5)
  v_cndmask_b32 v16, v16, v12, s[84:85]
  v_cndmask_b32 v17, v17, v12, s[84:85]
  v_cndmask_b32 v18, v18, v12, s[84:85]
  v_cndmask_b32 v19, v19, v12, s[84:85]
  ds_read_b64_tr_b16 v[80:81], v8 offset:12416
  s_waitcnt lgkmcnt(4)
  v_mfma_f32_16x16x32_bf16 v[88:91], v[40:43], v[20:23], v[88:91]
  ds_read_b64_tr_b16 v[82:83], v8 offset:13952
  v_mfma_f32_16x16x32_bf16 v[92:95], v[40:43], v[24:27], v[92:95]
  ds_read_b128 v[56:59], v5 offset:2048
  s_waitcnt lgkmcnt(5)
  v_mfma_f32_16x16x32_bf16 v[116:119], v[44:47], v[28:31], v[116:119]
  v_mfma_f32_16x16x32_bf16 v[136:139], v[28:31], v[48:51], v[136:139]
  ds_read_b128 v[60:63], v5 offset:4096
  v_mfma_f32_16x16x32_bf16 v[96:99], v[40:43], v[28:31], v[96:99]
  ds_read_b64_tr_b16 v[84:85], v8 offset:12544
  v_mfma_f32_16x16x32_bf16 v[104:107], v[44:47], v[16:19], v[104:107]
  ds_read_b64_tr_b16 v[86:87], v8 offset:14080
  v_mfma_f32_16x16x32_bf16 v[124:127], v[16:19], v[48:51], v[124:127]
  v_mfma_f32_16x16x32_bf16 v[144:147], v[40:43], v[16:19], v[144:147]
  ds_read_b128 v[52:55], v5 offset:0
  v_mfma_f32_16x16x32_bf16 v[168:171], v[16:19], v[16:19], v[168:171]
  ds_read_b64_tr_b16 v[76:77], v8 offset:12288
  s_waitcnt lgkmcnt(9)
  v_mfma_f32_16x16x32_bf16 v[120:123], v[44:47], v[32:35], v[120:123]
  ds_read_b64_tr_b16 v[78:79], v8 offset:13824
  v_mfma_f32_16x16x32_bf16 v[140:143], v[32:35], v[48:51], v[140:143]
  v_mfma_f32_16x16x32_bf16 v[100:103], v[40:43], v[32:35], v[100:103]
  ds_read_b128 v[64:67], v5 offset:6144
  s_waitcnt lgkmcnt(10)
  v_mfma_f32_16x16x32_bf16 v[156:159], v[12:15], v[36:39], v[156:159]
  ds_read_b128 v[68:71], v5 offset:8192
  v_mfma_f32_16x16x32_bf16 v[160:163], v[36:39], v[36:39], v[160:163]
  ds_read_b128 v[72:75], v7
  s_waitcnt lgkmcnt(9)
  v_mfma_f32_16x16x32_bf16 v[108:111], v[80:83], v[56:59], v[108:111]
  s_waitcnt lgkmcnt(8)
  v_mfma_f32_16x16x32_bf16 v[112:115], v[80:83], v[60:63], v[112:115]
  s_waitcnt lgkmcnt(6)
  v_mfma_f32_16x16x32_bf16 v[128:131], v[56:59], v[84:87], v[128:131]
  v_mfma_f32_16x16x32_bf16 v[132:135], v[60:63], v[84:87], v[132:135]
  s_waitcnt lgkmcnt(5)
  v_cndmask_b32 v52, v52, v12, s[84:85]
  v_cndmask_b32 v53, v53, v12, s[84:85]
  v_cndmask_b32 v54, v54, v12, s[84:85]
  v_cndmask_b32 v55, v55, v12, s[84:85]
  s_waitcnt lgkmcnt(3)
  v_mfma_f32_16x16x32_bf16 v[88:91], v[76:79], v[56:59], v[88:91]
  v_mfma_f32_16x16x32_bf16 v[92:95], v[76:79], v[60:63], v[92:95]
  s_waitcnt lgkmcnt(2)
  v_mfma_f32_16x16x32_bf16 v[116:119], v[80:83], v[64:67], v[116:119]
  v_mfma_f32_16x16x32_bf16 v[136:139], v[64:67], v[84:87], v[136:139]
  v_mfma_f32_16x16x32_bf16 v[96:99], v[76:79], v[64:67], v[96:99]
  v_add_u32 v4, 34816, v4
  v_add_u32 v5, 34816, v5
  v_add_u32 v6, 34816, v6
  v_add_u32 v7, 34816, v7
  v_add_u32 v8, 34816, v8
  s_waitcnt lgkmcnt(0)
  s_barrier
  v_mfma_f32_16x16x32_bf16 v[104:107], v[80:83], v[52:55], v[104:107]
  ds_read_b64_tr_b16 v[44:45], v8 offset:128
  v_mfma_f32_16x16x32_bf16 v[124:127], v[52:55], v[84:87], v[124:127]
  ds_read_b64_tr_b16 v[46:47], v8 offset:1664
  v_mfma_f32_16x16x32_bf16 v[144:147], v[76:79], v[52:55], v[144:147]
  ds_read_b128 v[20:23], v4 offset:2048
  ds_read_b128 v[24:27], v4 offset:4096
  v_mfma_f32_16x16x32_bf16 v[168:171], v[52:55], v[52:55], v[168:171]
  ds_read_b64_tr_b16 v[48:49], v8 offset:256
  v_mfma_f32_16x16x32_bf16 v[120:123], v[80:83], v[68:71], v[120:123]
  ds_read_b64_tr_b16 v[50:51], v8 offset:1792
  v_mfma_f32_16x16x32_bf16 v[140:143], v[68:71], v[84:87], v[140:143]
  ds_read_b128 v[16:19], v4 offset:0
  ds_read_b64_tr_b16 v[40:41], v8 offset:0
  v_mfma_f32_16x16x32_bf16 v[100:103], v[76:79], v[68:71], v[100:103]
  ds_read_b64_tr_b16 v[42:43], v8 offset:1536
  v_mfma_f32_16x16x32_bf16 v[156:159], v[12:15], v[72:75], v[156:159]
  ds_read_b128 v[28:31], v4 offset:6144
  v_mfma_f32_16x16x32_bf16 v[160:163], v[72:75], v[72:75], v[160:163]
  ds_read_b128 v[32:35], v4 offset:8192
  ds_read_b128 v[36:39], v6
  s_waitcnt lgkmcnt(9)
  v_mfma_f32_16x16x32_bf16 v[108:111], v[44:47], v[20:23], v[108:111]
  s_waitcnt lgkmcnt(8)
  v_mfma_f32_16x16x32_bf16 v[112:115], v[44:47], v[24:27], v[112:115]
  s_waitcnt lgkmcnt(6)
  v_mfma_f32_16x16x32_bf16 v[128:131], v[20:23], v[48:51], v[128:131]
  v_mfma_f32_16x16x32_bf16 v[132:135], v[24:27], v[48:51], v[132:135]
  s_waitcnt lgkmcnt(5)
  v_cndmask_b32 v16, v16, v12, s[84:85]
  v_cndmask_b32 v17, v17, v12, s[84:85]
  v_cndmask_b32 v18, v18, v12, s[84:85]
  v_cndmask_b32 v19, v19, v12, s[84:85]
  ds_read_b64_tr_b16 v[80:81], v8 offset:12416
  s_waitcnt lgkmcnt(4)
  v_mfma_f32_16x16x32_bf16 v[88:91], v[40:43], v[20:23], v[88:91]
  ds_read_b64_tr_b16 v[82:83], v8 offset:13952
  v_mfma_f32_16x16x32_bf16 v[92:95], v[40:43], v[24:27], v[92:95]
  ds_read_b128 v[56:59], v5 offset:2048
  s_waitcnt lgkmcnt(5)
  v_mfma_f32_16x16x32_bf16 v[116:119], v[44:47], v[28:31], v[116:119]
  v_mfma_f32_16x16x32_bf16 v[136:139], v[28:31], v[48:51], v[136:139]
  ds_read_b128 v[60:63], v5 offset:4096
  v_mfma_f32_16x16x32_bf16 v[96:99], v[40:43], v[28:31], v[96:99]
  ds_read_b64_tr_b16 v[84:85], v8 offset:12544
  v_mfma_f32_16x16x32_bf16 v[104:107], v[44:47], v[16:19], v[104:107]
  ds_read_b64_tr_b16 v[86:87], v8 offset:14080
  v_mfma_f32_16x16x32_bf16 v[124:127], v[16:19], v[48:51], v[124:127]
  v_mfma_f32_16x16x32_bf16 v[144:147], v[40:43], v[16:19], v[144:147]
  ds_read_b128 v[52:55], v5 offset:0
  v_mfma_f32_16x16x32_bf16 v[168:171], v[16:19], v[16:19], v[168:171]
  ds_read_b64_tr_b16 v[76:77], v8 offset:12288
  s_waitcnt lgkmcnt(9)
  v_mfma_f32_16x16x32_bf16 v[120:123], v[44:47], v[32:35], v[120:123]
  ds_read_b64_tr_b16 v[78:79], v8 offset:13824
  v_mfma_f32_16x16x32_bf16 v[140:143], v[32:35], v[48:51], v[140:143]
  v_mfma_f32_16x16x32_bf16 v[100:103], v[40:43], v[32:35], v[100:103]
  ds_read_b128 v[64:67], v5 offset:6144
  s_waitcnt lgkmcnt(10)
  v_mfma_f32_16x16x32_bf16 v[156:159], v[12:15], v[36:39], v[156:159]
  ds_read_b128 v[68:71], v5 offset:8192
  v_mfma_f32_16x16x32_bf16 v[160:163], v[36:39], v[36:39], v[160:163]
  ds_read_b128 v[72:75], v7
  s_waitcnt lgkmcnt(9)
  v_mfma_f32_16x16x32_bf16 v[108:111], v[80:83], v[56:59], v[108:111]
  s_waitcnt lgkmcnt(8)
  v_mfma_f32_16x16x32_bf16 v[112:115], v[80:83], v[60:63], v[112:115]
  s_waitcnt lgkmcnt(6)
  v_mfma_f32_16x16x32_bf16 v[128:131], v[56:59], v[84:87], v[128:131]
  v_mfma_f32_16x16x32_bf16 v[132:135], v[60:63], v[84:87], v[132:135]
  s_waitcnt lgkmcnt(5)
  v_cndmask_b32 v52, v52, v12, s[84:85]
  v_cndmask_b32 v53, v53, v12, s[84:85]
  v_cndmask_b32 v54, v54, v12, s[84:85]
  v_cndmask_b32 v55, v55, v12, s[84:85]
  s_waitcnt lgkmcnt(3)
  v_mfma_f32_16x16x32_bf16 v[88:91], v[76:79], v[56:59], v[88:91]
  v_mfma_f32_16x16x32_bf16 v[92:95], v[76:79], v[60:63], v[92:95]
  s_waitcnt lgkmcnt(2)
  v_mfma_f32_16x16x32_bf16 v[116:119], v[80:83], v[64:67], v[116:119]
  v_mfma_f32_16x16x32_bf16 v[136:139], v[64:67], v[84:87], v[136:139]
  v_mfma_f32_16x16x32_bf16 v[96:99], v[76:79], v[64:67], v[96:99]
  v_add_u32 v4, 34816, v4
  v_add_u32 v5, 34816, v5
  v_add_u32 v6, 34816, v6
  v_add_u32 v7, 34816, v7
  v_add_u32 v8, 34816, v8
  s_waitcnt lgkmcnt(0)
  s_barrier
  v_mfma_f32_16x16x32_bf16 v[104:107], v[80:83], v[52:55], v[104:107]
  ds_read_b64_tr_b16 v[44:45], v8 offset:128
  v_mfma_f32_16x16x32_bf16 v[124:127], v[52:55], v[84:87], v[124:127]
  ds_read_b64_tr_b16 v[46:47], v8 offset:1664
  v_mfma_f32_16x16x32_bf16 v[144:147], v[76:79], v[52:55], v[144:147]
  ds_read_b128 v[20:23], v4 offset:2048
  ds_read_b128 v[24:27], v4 offset:4096
  v_mfma_f32_16x16x32_bf16 v[168:171], v[52:55], v[52:55], v[168:171]
  ds_read_b64_tr_b16 v[48:49], v8 offset:256
  v_mfma_f32_16x16x32_bf16 v[120:123], v[80:83], v[68:71], v[120:123]
  ds_read_b64_tr_b16 v[50:51], v8 offset:1792
  v_mfma_f32_16x16x32_bf16 v[140:143], v[68:71], v[84:87], v[140:143]
  ds_read_b128 v[16:19], v4 offset:0
  ds_read_b64_tr_b16 v[40:41], v8 offset:0
  v_mfma_f32_16x16x32_bf16 v[100:103], v[76:79], v[68:71], v[100:103]
  ds_read_b64_tr_b16 v[42:43], v8 offset:1536
  v_mfma_f32_16x16x32_bf16 v[156:159], v[12:15], v[72:75], v[156:159]
  ds_read_b128 v[28:31], v4 offset:6144
  v_mfma_f32_16x16x32_bf16 v[160:163], v[72:75], v[72:75], v[160:163]
  ds_read_b128 v[32:35], v4 offset:8192
  ds_read_b128 v[36:39], v6
  s_waitcnt lgkmcnt(9)
  v_mfma_f32_16x16x32_bf16 v[108:111], v[44:47], v[20:23], v[108:111]
  s_waitcnt lgkmcnt(8)
  v_mfma_f32_16x16x32_bf16 v[112:115], v[44:47], v[24:27], v[112:115]
  s_waitcnt lgkmcnt(6)
  v_mfma_f32_16x16x32_bf16 v[128:131], v[20:23], v[48:51], v[128:131]
  v_mfma_f32_16x16x32_bf16 v[132:135], v[24:27], v[48:51], v[132:135]
  s_waitcnt lgkmcnt(5)
  v_cndmask_b32 v16, v16, v12, s[84:85]
  v_cndmask_b32 v17, v17, v12, s[84:85]
  v_cndmask_b32 v18, v18, v12, s[84:85]
  v_cndmask_b32 v19, v19, v12, s[84:85]
  ds_read_b64_tr_b16 v[80:81], v8 offset:12416
  s_waitcnt lgkmcnt(4)
  v_mfma_f32_16x16x32_bf16 v[88:91], v[40:43], v[20:23], v[88:91]
  ds_read_b64_tr_b16 v[82:83], v8 offset:13952
  v_mfma_f32_16x16x32_bf16 v[92:95], v[40:43], v[24:27], v[92:95]
  ds_read_b128 v[56:59], v5 offset:2048
  s_waitcnt lgkmcnt(5)
  v_mfma_f32_16x16x32_bf16 v[116:119], v[44:47], v[28:31], v[116:119]
  v_mfma_f32_16x16x32_bf16 v[136:139], v[28:31], v[48:51], v[136:139]
  ds_read_b128 v[60:63], v5 offset:4096
  v_mfma_f32_16x16x32_bf16 v[96:99], v[40:43], v[28:31], v[96:99]
  ds_read_b64_tr_b16 v[84:85], v8 offset:12544
  v_mfma_f32_16x16x32_bf16 v[104:107], v[44:47], v[16:19], v[104:107]
  ds_read_b64_tr_b16 v[86:87], v8 offset:14080
  v_mfma_f32_16x16x32_bf16 v[124:127], v[16:19], v[48:51], v[124:127]
  v_mfma_f32_16x16x32_bf16 v[144:147], v[40:43], v[16:19], v[144:147]
  ds_read_b128 v[52:55], v5 offset:0
  v_mfma_f32_16x16x32_bf16 v[168:171], v[16:19], v[16:19], v[168:171]
  ds_read_b64_tr_b16 v[76:77], v8 offset:12288
  s_waitcnt lgkmcnt(9)
  v_mfma_f32_16x16x32_bf16 v[120:123], v[44:47], v[32:35], v[120:123]
  ds_read_b64_tr_b16 v[78:79], v8 offset:13824
  v_mfma_f32_16x16x32_bf16 v[140:143], v[32:35], v[48:51], v[140:143]
  v_mfma_f32_16x16x32_bf16 v[100:103], v[40:43], v[32:35], v[100:103]
  ds_read_b128 v[64:67], v5 offset:6144
  s_waitcnt lgkmcnt(10)
  v_mfma_f32_16x16x32_bf16 v[156:159], v[12:15], v[36:39], v[156:159]
  ds_read_b128 v[68:71], v5 offset:8192
  v_mfma_f32_16x16x32_bf16 v[160:163], v[36:39], v[36:39], v[160:163]
  ds_read_b128 v[72:75], v7
  s_waitcnt lgkmcnt(9)
  v_mfma_f32_16x16x32_bf16 v[108:111], v[80:83], v[56:59], v[108:111]
  s_waitcnt lgkmcnt(8)
  v_mfma_f32_16x16x32_bf16 v[112:115], v[80:83], v[60:63], v[112:115]
  s_waitcnt lgkmcnt(6)
  v_mfma_f32_16x16x32_bf16 v[128:131], v[56:59], v[84:87], v[128:131]
  v_mfma_f32_16x16x32_bf16 v[132:135], v[60:63], v[84:87], v[132:135]
  s_waitcnt lgkmcnt(5)
  v_cndmask_b32 v52, v52, v12, s[84:85]
  v_cndmask_b32 v53, v53, v12, s[84:85]
  v_cndmask_b32 v54, v54, v12, s[84:85]
  v_cndmask_b32 v55, v55, v12, s[84:85]
  s_waitcnt lgkmcnt(0)
  v_mfma_f32_16x16x32_bf16 v[156:159], v[12:15], v[72:75], v[156:159]
  v_mfma_f32_16x16x32_bf16 v[160:163], v[72:75], v[72:75], v[160:163]
  v_mfma_f32_16x16x32_bf16 v[168:171], v[52:55], v[52:55], v[168:171]
  v_mfma_f32_16x16x32_bf16 v[104:107], v[80:83], v[52:55], v[104:107]
  v_mfma_f32_16x16x32_bf16 v[124:127], v[52:55], v[84:87], v[124:127]
  v_mfma_f32_16x16x32_bf16 v[144:147], v[76:79], v[52:55], v[144:147]
  s_nop 3
  v_cndmask_b32 v16, v160, v161, s[90:91]
  v_cndmask_b32 v16, v16, v162, s[92:93]
  v_mfma_f32_16x16x32_bf16 v[88:91], v[76:79], v[56:59], v[88:91]
  v_cndmask_b32 v16, v16, v163, s[94:95]
  v_mul_f32 v18, 0x3b000000, v156
  v_mul_f32 v16, 0x3b000000, v16
  v_mfma_f32_16x16x32_bf16 v[92:95], v[76:79], v[60:63], v[92:95]
  v_fma_f32 v16, -v18, v18, v16
  v_max_f32 v16, 0, v16
  v_mfma_f32_16x16x32_bf16 v[116:119], v[80:83], v[64:67], v[116:119]
  v_add_f32 v16, 0x3727c5ac, v16
  v_rsq_f32 v19, v16
  v_mov_b32 v164, v168
  v_mfma_f32_16x16x32_bf16 v[136:139], v[64:67], v[84:87], v[136:139]
  v_mov_b32 v25, v168
  s_nop 1
  v_permlane16_swap_b32 v164, v25
  v_mfma_f32_16x16x32_bf16 v[96:99], v[76:79], v[64:67], v[96:99]
  v_mov_b32 v25, v164
  s_nop 1
  v_permlane32_swap_b32 v164, v25
  v_cndmask_b32 v20, v168, v169, s[90:91]
  v_mfma_f32_16x16x32_bf16 v[120:123], v[80:83], v[68:71], v[120:123]
  v_cndmask_b32 v20, v20, v170, s[92:93]
  v_cndmask_b32 v20, v20, v171, s[94:95]
  v_mfma_f32_16x16x32_bf16 v[140:143], v[68:71], v[84:87], v[140:143]
  v_mul_f32 v22, 0x3b000000, v164
  v_mul_f32 v20, 0x3b000000, v20
  v_fma_f32 v20, -v22, v22, v20
  v_mfma_f32_16x16x32_bf16 v[100:103], v[76:79], v[68:71], v[100:103]
  v_max_f32 v20, 0, v20
  v_add_f32 v20, 0x3727c5ac, v20
  v_rsq_f32 v23, v20
  s_lshl_b32 s62, s57, 4
  v_mov_b32 v9, s62
  global_load_dword v190, v9, s[22:23] sc1
  v_lshlrev_b32 v9, 2, v2
  v_add_u32 v9, 159744, v9
  s_add_u32 s62, s56, 1
  s_lshl_b32 s62, s62, 7
  v_add_u32 v10, s62, v9
  s_mov_b64 exec, s[96:97]
  ds_write2_b32 v10, v18, v19 offset0:0 offset1:16
  ds_write2_b32 v9, v22, v23 offset0:0 offset1:16
  s_mov_b64 exec, -1
  s_waitcnt lgkmcnt(0)
  s_barrier
  v_lshlrev_b32 v10, 4, v3
  v_add_u32 v10, 159744, v10
  ds_read2_b32 v[192:193], v9 offset0:0 offset1:16
  ds_read2_b32 v[194:195], v9 offset0:32 offset1:48
  ds_read2_b32 v[196:197], v9 offset0:64 offset1:80
  ds_read2_b32 v[198:199], v9 offset0:96 offset1:112
  ds_read2_b32 v[200:201], v9 offset0:128 offset1:144
  ds_read_b128 v[16:19], v10 offset:0
  ds_read_b128 v[20:23], v10 offset:64
  ds_read_b128 v[24:27], v10 offset:128
  ds_read_b128 v[28:31], v10 offset:192
  ds_read_b128 v[32:35], v10 offset:256
  ds_read_b128 v[36:39], v10 offset:320
  ds_read_b128 v[40:43], v10 offset:384
  ds_read_b128 v[44:47], v10 offset:448
  ds_read_b128 v[48:51], v10 offset:512
  ds_read_b128 v[52:55], v10 offset:576
  v_mov_b32_dpp v148, v104 row_newbcast:0 row_mask:0xf bank_mask:0xf
  v_mov_b32_dpp v149, v105 row_newbcast:0 row_mask:0xf bank_mask:0xf
  v_mov_b32_dpp v150, v106 row_newbcast:0 row_mask:0xf bank_mask:0xf
  v_mov_b32_dpp v151, v107 row_newbcast:0 row_mask:0xf bank_mask:0xf
  v_mov_b32_dpp v144, v144 row_newbcast:0 row_mask:0xf bank_mask:0xf
  v_mov_b32_dpp v145, v145 row_newbcast:0 row_mask:0xf bank_mask:0xf
  v_mov_b32_dpp v146, v146 row_newbcast:0 row_mask:0xf bank_mask:0xf
  v_mov_b32_dpp v147, v147 row_newbcast:0 row_mask:0xf bank_mask:0xf
  v_mov_b32 v152, v124
  v_mov_b32 v202, v124
  s_nop 1
  v_permlane16_swap_b32 v152, v202
  v_mov_b32 v202, v152
  s_nop 1
  v_permlane32_swap_b32 v152, v202
  s_waitcnt lgkmcnt(14)
  v_pk_fma_f32 v[104:105], v[192:193], v[148:149], v[104:105] op_sel_hi:[0,1,1] neg_lo:[1,0,0] neg_hi:[1,0,0]
  v_pk_fma_f32 v[106:107], v[192:193], v[150:151], v[106:107] op_sel_hi:[0,1,1] neg_lo:[1,0,0] neg_hi:[1,0,0]
  v_pk_mul_f32 v[104:105], v[104:105], v[192:193] op_sel:[0,1] op_sel_hi:[1,1]
  v_pk_mul_f32 v[106:107], v[106:107], v[192:193] op_sel:[0,1] op_sel_hi:[1,1]
  s_waitcnt lgkmcnt(13)
  v_pk_fma_f32 v[108:109], v[194:195], v[148:149], v[108:109] op_sel_hi:[0,1,1] neg_lo:[1,0,0] neg_hi:[1,0,0]
  v_pk_fma_f32 v[110:111], v[194:195], v[150:151], v[110:111] op_sel_hi:[0,1,1] neg_lo:[1,0,0] neg_hi:[1,0,0]
  v_pk_mul_f32 v[108:109], v[108:109], v[194:195] op_sel:[0,1] op_sel_hi:[1,1]
  v_pk_mul_f32 v[110:111], v[110:111], v[194:195] op_sel:[0,1] op_sel_hi:[1,1]
  s_waitcnt lgkmcnt(12)
  v_pk_fma_f32 v[112:113], v[196:197], v[148:149], v[112:113] op_sel_hi:[0,1,1] neg_lo:[1,0,0] neg_hi:[1,0,0]
  v_pk_fma_f32 v[114:115], v[196:197], v[150:151], v[114:115] op_sel_hi:[0,1,1] neg_lo:[1,0,0] neg_hi:[1,0,0]
  v_pk_mul_f32 v[112:113], v[112:113], v[196:197] op_sel:[0,1] op_sel_hi:[1,1]
  v_pk_mul_f32 v[114:115], v[114:115], v[196:197] op_sel:[0,1] op_sel_hi:[1,1]
  s_waitcnt lgkmcnt(11)
  v_pk_fma_f32 v[116:117], v[198:199], v[148:149], v[116:117] op_sel_hi:[0,1,1] neg_lo:[1,0,0] neg_hi:[1,0,0]
  v_pk_fma_f32 v[118:119], v[198:199], v[150:151], v[118:119] op_sel_hi:[0,1,1] neg_lo:[1,0,0] neg_hi:[1,0,0]
  v_pk_mul_f32 v[116:117], v[116:117], v[198:199] op_sel:[0,1] op_sel_hi:[1,1]
  v_pk_mul_f32 v[118:119], v[118:119], v[198:199] op_sel:[0,1] op_sel_hi:[1,1]
  s_waitcnt lgkmcnt(10)
  v_pk_fma_f32 v[120:121], v[200:201], v[148:149], v[120:121] op_sel_hi:[0,1,1] neg_lo:[1,0,0] neg_hi:[1,0,0]
  v_pk_fma_f32 v[122:123], v[200:201], v[150:151], v[122:123] op_sel_hi:[0,1,1] neg_lo:[1,0,0] neg_hi:[1,0,0]
  v_pk_mul_f32 v[120:121], v[120:121], v[200:201] op_sel:[0,1] op_sel_hi:[1,1]
  v_pk_mul_f32 v[122:123], v[122:123], v[200:201] op_sel:[0,1] op_sel_hi:[1,1]
  v_cvt_pk_bf16_f32 v64, v104, v105
  v_cvt_pk_bf16_f32 v65, v106, v107
  v_cvt_pk_bf16_f32 v66, v108, v109
  v_cvt_pk_bf16_f32 v67, v110, v111
  v_cvt_pk_bf16_f32 v68, v112, v113
  v_cvt_pk_bf16_f32 v69, v114, v115
  v_cvt_pk_bf16_f32 v70, v116, v117
  v_cvt_pk_bf16_f32 v71, v118, v119
  v_cvt_pk_bf16_f32 v72, v120, v121
  v_cvt_pk_bf16_f32 v73, v122, v123
  v_pk_fma_f32 v[88:89], v[194:195], v[144:145], v[88:89] op_sel_hi:[0,1,1] neg_lo:[1,0,0] neg_hi:[1,0,0]
  v_pk_fma_f32 v[90:91], v[194:195], v[146:147], v[90:91] op_sel_hi:[0,1,1] neg_lo:[1,0,0] neg_hi:[1,0,0]
  v_pk_fma_f32 v[92:93], v[196:197], v[144:145], v[92:93] op_sel_hi:[0,1,1] neg_lo:[1,0,0] neg_hi:[1,0,0]
  v_pk_fma_f32 v[94:95], v[196:197], v[146:147], v[94:95] op_sel_hi:[0,1,1] neg_lo:[1,0,0] neg_hi:[1,0,0]
  v_pk_fma_f32 v[96:97], v[198:199], v[144:145], v[96:97] op_sel_hi:[0,1,1] neg_lo:[1,0,0] neg_hi:[1,0,0]
  v_pk_fma_f32 v[98:99], v[198:199], v[146:147], v[98:99] op_sel_hi:[0,1,1] neg_lo:[1,0,0] neg_hi:[1,0,0]
  v_pk_fma_f32 v[100:101], v[200:201], v[144:145], v[100:101] op_sel_hi:[0,1,1] neg_lo:[1,0,0] neg_hi:[1,0,0]
  v_pk_fma_f32 v[102:103], v[200:201], v[146:147], v[102:103] op_sel_hi:[0,1,1] neg_lo:[1,0,0] neg_hi:[1,0,0]
  v_cvt_pk_bf16_f32 v56, v88, v89
  v_cvt_pk_bf16_f32 v57, v90, v91
  v_mul_f32 v240, 0x3eb8aa3b, v195
  v_cvt_pk_bf16_f32 v58, v92, v93
  v_cvt_pk_bf16_f32 v59, v94, v95
  v_mul_f32 v242, 0x3eb8aa3b, v197
  v_cvt_pk_bf16_f32 v60, v96, v97
  v_cvt_pk_bf16_f32 v61, v98, v99
  v_mul_f32 v244, 0x3eb8aa3b, v199
  v_cvt_pk_bf16_f32 v62, v100, v101
  v_cvt_pk_bf16_f32 v63, v102, v103
  v_mul_f32 v246, 0x3eb8aa3b, v201
  s_waitcnt lgkmcnt(9)
  v_pk_fma_f32 v[124:125], v[16:17], v[152:153], v[124:125] op_sel_hi:[1,0,1] neg_lo:[1,0,0] neg_hi:[1,0,0]
  v_pk_fma_f32 v[126:127], v[18:19], v[152:153], v[126:127] op_sel_hi:[1,0,1] neg_lo:[1,0,0] neg_hi:[1,0,0]
  s_waitcnt lgkmcnt(8)
  v_pk_mul_f32 v[124:125], v[124:125], v[20:21]
  v_pk_mul_f32 v[126:127], v[126:127], v[22:23]
  s_waitcnt lgkmcnt(7)
  v_pk_fma_f32 v[128:129], v[24:25], v[152:153], v[128:129] op_sel_hi:[1,0,1] neg_lo:[1,0,0] neg_hi:[1,0,0]
  v_pk_fma_f32 v[130:131], v[26:27], v[152:153], v[130:131] op_sel_hi:[1,0,1] neg_lo:[1,0,0] neg_hi:[1,0,0]
  s_waitcnt lgkmcnt(6)
  v_pk_mul_f32 v[128:129], v[128:129], v[28:29]
  v_pk_mul_f32 v[130:131], v[130:131], v[30:31]
  s_waitcnt lgkmcnt(5)
  v_pk_fma_f32 v[132:133], v[32:33], v[152:153], v[132:133] op_sel_hi:[1,0,1] neg_lo:[1,0,0] neg_hi:[1,0,0]
  v_pk_fma_f32 v[134:135], v[34:35], v[152:153], v[134:135] op_sel_hi:[1,0,1] neg_lo:[1,0,0] neg_hi:[1,0,0]
  s_waitcnt lgkmcnt(4)
  v_pk_mul_f32 v[132:133], v[132:133], v[36:37]
  v_pk_mul_f32 v[134:135], v[134:135], v[38:39]
  s_waitcnt lgkmcnt(3)
  v_pk_fma_f32 v[136:137], v[40:41], v[152:153], v[136:137] op_sel_hi:[1,0,1] neg_lo:[1,0,0] neg_hi:[1,0,0]
  v_pk_fma_f32 v[138:139], v[42:43], v[152:153], v[138:139] op_sel_hi:[1,0,1] neg_lo:[1,0,0] neg_hi:[1,0,0]
  s_waitcnt lgkmcnt(2)
  v_pk_mul_f32 v[136:137], v[136:137], v[44:45]
  v_pk_mul_f32 v[138:139], v[138:139], v[46:47]
  s_waitcnt lgkmcnt(1)
  v_pk_fma_f32 v[140:141], v[48:49], v[152:153], v[140:141] op_sel_hi:[1,0,1] neg_lo:[1,0,0] neg_hi:[1,0,0]
  v_pk_fma_f32 v[142:143], v[50:51], v[152:153], v[142:143] op_sel_hi:[1,0,1] neg_lo:[1,0,0] neg_hi:[1,0,0]
  s_waitcnt lgkmcnt(0)
  v_pk_mul_f32 v[140:141], v[140:141], v[52:53]
  v_pk_mul_f32 v[142:143], v[142:143], v[54:55]
  v_cvt_pk_bf16_f32 v74, v124, v125
  v_cvt_pk_bf16_f32 v75, v126, v127
  v_cvt_pk_bf16_f32 v76, v128, v129
  v_cvt_pk_bf16_f32 v77, v130, v131
  v_cvt_pk_bf16_f32 v78, v132, v133
  v_cvt_pk_bf16_f32 v79, v134, v135
  v_cvt_pk_bf16_f32 v80, v136, v137
  v_cvt_pk_bf16_f32 v81, v138, v139
  v_cvt_pk_bf16_f32 v82, v140, v141
  v_cvt_pk_bf16_f32 v83, v142, v143
  v_mfma_f32_16x16x16_bf16 v[208:211], v[66:67], v[56:57], v[172:175]
  v_mfma_f32_16x16x16_bf16 v[224:227], v[64:65], v[56:57], v[180:183]
  v_mfma_f32_16x16x16_bf16 v[212:215], v[68:69], v[58:59], v[172:175]
  v_mfma_f32_16x16x16_bf16 v[228:231], v[64:65], v[58:59], v[184:187]
  v_mfma_f32_16x16x16_bf16 v[216:219], v[70:71], v[60:61], v[172:175]
  v_mfma_f32_16x16x16_bf16 v[232:235], v[66:67], v[60:61], v[176:179]
  v_mfma_f32_16x16x16_bf16 v[220:223], v[72:73], v[62:63], v[172:175]
  v_mfma_f32_16x16x16_bf16 v[236:239], v[68:69], v[62:63], v[176:179]
  s_nop 1
  v_max_f32 v208, v208, v224
  v_max_f32 v209, v209, v225
  v_max_f32 v210, v210, v226
  v_max_f32 v211, v211, v227
  v_max_f32 v212, v212, v228
  v_max_f32 v213, v213, v229
  v_max_f32 v214, v214, v230
  v_max_f32 v215, v215, v231
  v_max_f32 v216, v216, v232
  v_max_f32 v217, v217, v233
  v_max_f32 v218, v218, v234
  v_max_f32 v219, v219, v235
  v_max_f32 v220, v220, v236
  v_max_f32 v221, v221, v237
  v_max_f32 v222, v222, v238
  v_max_f32 v223, v223, v239
  v_max3_f32 v88, v208, v209, v210
  v_max3_f32 v89, v212, v213, v214
  v_max3_f32 v90, v216, v217, v218
  v_max3_f32 v91, v220, v221, v222
  v_max_f32 v88, v88, v211
  v_max_f32 v89, v89, v215
  v_max_f32 v90, v90, v219
  v_max_f32 v91, v91, v223
  v_mov_b32 v92, v88
  v_mov_b32 v93, v89
  v_mov_b32 v94, v90
  v_mov_b32 v95, v91
  v_permlane32_swap_b32 v88, v92
  v_permlane32_swap_b32 v89, v93
  v_permlane32_swap_b32 v90, v94
  v_permlane32_swap_b32 v91, v95
  v_max_f32 v88, v88, v92
  v_max_f32 v89, v89, v93
  v_max_f32 v90, v90, v94
  v_max_f32 v91, v91, v95
  v_mov_b32 v92, v88
  v_mov_b32 v93, v89
  v_mov_b32 v94, v90
  v_mov_b32 v95, v91
  v_permlane16_swap_b32 v88, v92
  v_permlane16_swap_b32 v89, v93
  v_permlane16_swap_b32 v90, v94
  v_permlane16_swap_b32 v91, v95
  v_max_f32 v88, v88, v92
  v_max_f32 v89, v89, v93
  v_max_f32 v90, v90, v94
  v_max_f32 v91, v91, v95
  v_mul_f32 v24, v88, v240
  v_mul_f32 v26, v89, v242
  v_mul_f32 v28, v90, v244
  v_mul_f32 v30, v91, v246
  v_pk_fma_f32 v[208:209], v[208:209], v[240:241], v[24:25] op_sel_hi:[1,0,0] neg_lo:[0,0,1] neg_hi:[0,0,1]
  v_pk_fma_f32 v[210:211], v[210:211], v[240:241], v[24:25] op_sel_hi:[1,0,0] neg_lo:[0,0,1] neg_hi:[0,0,1]
  v_pk_fma_f32 v[212:213], v[212:213], v[242:243], v[26:27] op_sel_hi:[1,0,0] neg_lo:[0,0,1] neg_hi:[0,0,1]
  v_pk_fma_f32 v[214:215], v[214:215], v[242:243], v[26:27] op_sel_hi:[1,0,0] neg_lo:[0,0,1] neg_hi:[0,0,1]
  v_pk_fma_f32 v[216:217], v[216:217], v[244:245], v[28:29] op_sel_hi:[1,0,0] neg_lo:[0,0,1] neg_hi:[0,0,1]
  v_pk_fma_f32 v[218:219], v[218:219], v[244:245], v[28:29] op_sel_hi:[1,0,0] neg_lo:[0,0,1] neg_hi:[0,0,1]
  v_pk_fma_f32 v[220:221], v[220:221], v[246:247], v[30:31] op_sel_hi:[1,0,0] neg_lo:[0,0,1] neg_hi:[0,0,1]
  v_pk_fma_f32 v[222:223], v[222:223], v[246:247], v[30:31] op_sel_hi:[1,0,0] neg_lo:[0,0,1] neg_hi:[0,0,1]
  v_exp_f32 v208, v208
  v_exp_f32 v209, v209
  v_exp_f32 v210, v210
  v_exp_f32 v211, v211
  v_exp_f32 v212, v212
  v_exp_f32 v213, v213
  v_exp_f32 v214, v214
  v_exp_f32 v215, v215
  v_exp_f32 v216, v216
  v_exp_f32 v217, v217
  v_exp_f32 v218, v218
  v_exp_f32 v219, v219
  v_exp_f32 v220, v220
  v_exp_f32 v221, v221
  v_exp_f32 v222, v222
  v_exp_f32 v223, v223
  v_cvt_pk_bf16_f32 v100, v208, v209
  v_cvt_pk_bf16_f32 v101, v210, v211
  v_cvt_pk_bf16_f32 v102, v212, v213
  v_cvt_pk_bf16_f32 v103, v214, v215
  v_cvt_pk_bf16_f32 v104, v216, v217
  v_cvt_pk_bf16_f32 v105, v218, v219
  v_cvt_pk_bf16_f32 v106, v220, v221
  v_cvt_pk_bf16_f32 v107, v222, v223
  v_and_b32 v108, v100, v188
  v_and_b32 v109, v101, v189
  v_and_b32 v110, v102, v188
  v_and_b32 v111, v103, v189
  v_and_b32 v112, v104, v188
  v_and_b32 v113, v105, v189
  v_and_b32 v114, v106, v188
  v_and_b32 v115, v107, v189
  v_xor_b32 v116, v100, v108
  v_xor_b32 v117, v101, v109
  v_xor_b32 v118, v102, v110
  v_xor_b32 v119, v103, v111
  v_xor_b32 v120, v104, v112
  v_xor_b32 v121, v105, v113
  v_xor_b32 v122, v106, v114
  v_xor_b32 v123, v107, v115
  v_mfma_f32_16x16x16_bf16 v[124:127], v[74:75], v[116:117], 0
  v_mfma_f32_16x16x16_bf16 v[140:143], v[12:13], v[116:117], 0
  v_mfma_f32_16x16x16_bf16 v[128:131], v[74:75], v[118:119], 0
  v_mfma_f32_16x16x16_bf16 v[144:147], v[12:13], v[118:119], 0
  v_mfma_f32_16x16x16_bf16 v[132:135], v[76:77], v[120:121], 0
  v_mfma_f32_16x16x16_bf16 v[148:151], v[12:13], v[120:121], 0
  v_mfma_f32_16x16x16_bf16 v[136:139], v[78:79], v[122:123], 0
  v_mfma_f32_16x16x16_bf16 v[152:155], v[12:13], v[122:123], 0
  v_mfma_f32_16x16x16_bf16 v[124:127], v[76:77], v[108:109], v[124:127]
  v_mfma_f32_16x16x16_bf16 v[140:143], v[12:13], v[108:109], v[140:143]
  v_mfma_f32_16x16x16_bf16 v[128:131], v[78:79], v[110:111], v[128:131]
  v_mfma_f32_16x16x16_bf16 v[144:147], v[12:13], v[110:111], v[144:147]
  v_mfma_f32_16x16x16_bf16 v[132:135], v[80:81], v[112:113], v[132:135]
  v_mfma_f32_16x16x16_bf16 v[148:151], v[12:13], v[112:113], v[148:151]
  v_mfma_f32_16x16x16_bf16 v[136:139], v[82:83], v[114:115], v[136:139]
  v_mfma_f32_16x16x16_bf16 v[152:155], v[12:13], v[114:115], v[152:155]
  s_lshl_b32 s62, s59, 16
  s_lshl_b32 s63, s60, 2
  s_add_u32 s63, s63, s56
  s_lshl_b32 s63, s63, 10
  s_add_u32 s62, s62, s63
  s_add_u32 s63, s62, 32768
  v_rcp_f32 v24, v140
  v_rcp_f32 v26, v144
  v_rcp_f32 v28, v148
  v_rcp_f32 v30, v152
  v_pk_mul_f32 v[124:125], v[124:125], v[24:25] op_sel_hi:[1,0]
  v_pk_mul_f32 v[126:127], v[126:127], v[24:25] op_sel_hi:[1,0]
  v_pk_mul_f32 v[128:129], v[128:129], v[26:27] op_sel_hi:[1,0]
  v_pk_mul_f32 v[130:131], v[130:131], v[26:27] op_sel_hi:[1,0]
  v_pk_mul_f32 v[132:133], v[132:133], v[28:29] op_sel_hi:[1,0]
  v_pk_mul_f32 v[134:135], v[134:135], v[28:29] op_sel_hi:[1,0]
  v_pk_mul_f32 v[136:137], v[136:137], v[30:31] op_sel_hi:[1,0]
  v_pk_mul_f32 v[138:139], v[138:139], v[30:31] op_sel_hi:[1,0]
  v_cvt_pk_bf16_f32 v156, v124, v125
  v_cvt_pk_bf16_f32 v157, v126, v127
  v_cvt_pk_bf16_f32 v158, v128, v129
  v_cvt_pk_bf16_f32 v159, v130, v131
  v_cvt_pk_bf16_f32 v160, v132, v133
  v_cvt_pk_bf16_f32 v161, v134, v135
  v_cvt_pk_bf16_f32 v162, v136, v137
  v_cvt_pk_bf16_f32 v163, v138, v139
  v_permlane16_swap_b32 v156, v158
  v_permlane16_swap_b32 v157, v159
  v_permlane16_swap_b32 v160, v162
  v_permlane16_swap_b32 v161, v163
  buffer_store_dwordx4 v[156:159], v1, s[48:51], s62 offen sc1
  buffer_store_dwordx4 v[160:163], v1, s[48:51], s63 offen sc1
  s_lshr_b32 s90, s56, 1
  s_and_b32 s91, s56, 1
  s_lshl_b32 s62, s91, 15
  v_lshrrev_b32 v2, 5, v0
  v_bfe_u32 v3, v0, 2, 2
  v_lshl_add_u32 v2, v2, 3, v3
  v_lshlrev_b32 v2, 7, v2
  v_lshrrev_b32 v3, 1, v3
  v_lshl_add_u32 v2, v3, 6, v2
  v_bfe_u32 v3, v0, 4, 1
  v_lshl_add_u32 v2, v3, 5, v2
  v_and_b32 v3, 3, v0
  v_lshl_add_u32 v2, v3, 3, v2
  v_add_u32 v2, s62, v2
  v_mov_b32 v4, v2
  v_xor_b32 v5, 64, v2
  s_lshl_b32 s62, s91, 6
  v_xor_b32 v4, s62, v4
  v_xor_b32 v5, 64, v4
  s_barrier
  ds_read_b64_tr_b16 v[16:17], v4 offset:0
  ds_read_b64_tr_b16 v[18:19], v4 offset:512
  ds_read_b64_tr_b16 v[20:21], v5 offset:0
  ds_read_b64_tr_b16 v[22:23], v5 offset:512
  ds_read_b64_tr_b16 v[24:25], v4 offset:2048
  ds_read_b64_tr_b16 v[26:27], v4 offset:2560
  ds_read_b64_tr_b16 v[28:29], v5 offset:2048
  ds_read_b64_tr_b16 v[30:31], v5 offset:2560
  ds_read_b64_tr_b16 v[32:33], v4 offset:4096
  ds_read_b64_tr_b16 v[34:35], v4 offset:4608
  ds_read_b64_tr_b16 v[36:37], v5 offset:4096
  ds_read_b64_tr_b16 v[38:39], v5 offset:4608
  ds_read_b64_tr_b16 v[40:41], v4 offset:6144
  ds_read_b64_tr_b16 v[42:43], v4 offset:6656
  ds_read_b64_tr_b16 v[44:45], v5 offset:6144
  s_waitcnt lgkmcnt(14)
  ds_read_b64_tr_b16 v[46:47], v5 offset:6656
  s_waitcnt lgkmcnt(14)
  ds_read_b64_tr_b16 v[48:49], v4 offset:8192
  s_waitcnt lgkmcnt(14)
  ds_read_b64_tr_b16 v[50:51], v4 offset:8704
  s_waitcnt lgkmcnt(14)
  ds_read_b64_tr_b16 v[52:53], v5 offset:8192
  s_waitcnt lgkmcnt(14)
  ds_read_b64_tr_b16 v[54:55], v5 offset:8704
  s_waitcnt lgkmcnt(14)
  ds_read_b64_tr_b16 v[56:57], v4 offset:10240
  s_waitcnt lgkmcnt(14)
  ds_read_b64_tr_b16 v[58:59], v4 offset:10752
  s_waitcnt lgkmcnt(14)
  ds_read_b64_tr_b16 v[60:61], v5 offset:10240
  s_waitcnt lgkmcnt(14)
  ds_read_b64_tr_b16 v[62:63], v5 offset:10752
  s_waitcnt lgkmcnt(14)
  ds_read_b64_tr_b16 v[64:65], v4 offset:12288
  s_waitcnt lgkmcnt(14)
  ds_read_b64_tr_b16 v[66:67], v4 offset:12800
  s_waitcnt lgkmcnt(14)
  ds_read_b64_tr_b16 v[68:69], v5 offset:12288
  s_waitcnt lgkmcnt(14)
  ds_read_b64_tr_b16 v[70:71], v5 offset:12800
  s_waitcnt lgkmcnt(14)
  ds_read_b64_tr_b16 v[72:73], v4 offset:14336
  s_waitcnt lgkmcnt(14)
  ds_read_b64_tr_b16 v[74:75], v4 offset:14848
  s_waitcnt lgkmcnt(14)
  ds_read_b64_tr_b16 v[76:77], v5 offset:14336
  s_waitcnt lgkmcnt(14)
  ds_read_b64_tr_b16 v[78:79], v5 offset:14848
  s_waitcnt lgkmcnt(14)
  ds_read_b64_tr_b16 v[80:81], v4 offset:16384
  s_waitcnt lgkmcnt(14)
  ds_read_b64_tr_b16 v[82:83], v4 offset:16896
  s_waitcnt lgkmcnt(14)
  ds_read_b64_tr_b16 v[84:85], v5 offset:16384
  s_waitcnt lgkmcnt(14)
  ds_read_b64_tr_b16 v[86:87], v5 offset:16896
  s_waitcnt lgkmcnt(14)
  ds_read_b64_tr_b16 v[88:89], v4 offset:18432
  s_waitcnt lgkmcnt(14)
  ds_read_b64_tr_b16 v[90:91], v4 offset:18944
  s_waitcnt lgkmcnt(14)
  ds_read_b64_tr_b16 v[92:93], v5 offset:18432
  s_waitcnt lgkmcnt(14)
  ds_read_b64_tr_b16 v[94:95], v5 offset:18944
  s_waitcnt lgkmcnt(14)
  ds_read_b64_tr_b16 v[96:97], v4 offset:20480
  s_waitcnt lgkmcnt(14)
  ds_read_b64_tr_b16 v[98:99], v4 offset:20992
  s_waitcnt lgkmcnt(14)
  ds_read_b64_tr_b16 v[100:101], v5 offset:20480
  s_waitcnt lgkmcnt(14)
  ds_read_b64_tr_b16 v[102:103], v5 offset:20992
  s_waitcnt lgkmcnt(14)
  ds_read_b64_tr_b16 v[104:105], v4 offset:22528
  s_waitcnt lgkmcnt(14)
  ds_read_b64_tr_b16 v[106:107], v4 offset:23040
  s_waitcnt lgkmcnt(14)
  ds_read_b64_tr_b16 v[108:109], v5 offset:22528
  s_waitcnt lgkmcnt(14)
  ds_read_b64_tr_b16 v[110:111], v5 offset:23040
  s_waitcnt lgkmcnt(14)
  ds_read_b64_tr_b16 v[112:113], v4 offset:24576
  s_waitcnt lgkmcnt(14)
  ds_read_b64_tr_b16 v[114:115], v4 offset:25088
  s_waitcnt lgkmcnt(14)
  ds_read_b64_tr_b16 v[116:117], v5 offset:24576
  s_waitcnt lgkmcnt(14)
  ds_read_b64_tr_b16 v[118:119], v5 offset:25088
  s_waitcnt lgkmcnt(14)
  ds_read_b64_tr_b16 v[120:121], v4 offset:26624
  s_waitcnt lgkmcnt(14)
  ds_read_b64_tr_b16 v[122:123], v4 offset:27136
  s_waitcnt lgkmcnt(14)
  ds_read_b64_tr_b16 v[124:125], v5 offset:26624
  s_waitcnt lgkmcnt(14)
  ds_read_b64_tr_b16 v[126:127], v5 offset:27136
  s_waitcnt lgkmcnt(14)
  ds_read_b64_tr_b16 v[128:129], v4 offset:28672
  s_waitcnt lgkmcnt(14)
  ds_read_b64_tr_b16 v[130:131], v4 offset:29184
  s_waitcnt lgkmcnt(14)
  ds_read_b64_tr_b16 v[132:133], v5 offset:28672
  s_waitcnt lgkmcnt(14)
  ds_read_b64_tr_b16 v[134:135], v5 offset:29184
  s_waitcnt lgkmcnt(14)
  ds_read_b64_tr_b16 v[136:137], v4 offset:30720
  s_waitcnt lgkmcnt(14)
  ds_read_b64_tr_b16 v[138:139], v4 offset:31232
  s_waitcnt lgkmcnt(14)
  ds_read_b64_tr_b16 v[140:141], v5 offset:30720
  s_waitcnt lgkmcnt(14)
  ds_read_b64_tr_b16 v[142:143], v5 offset:31232
  v_and_b32 v2, 31, v0
  s_lshl_b32 s62, s90, 5
  v_add_u32 v2, s62, v2
  v_lshrrev_b32 v3, 1, v2
  v_and_b32 v3, 7, v3
  s_lshl_b32 s62, s91, 2
  v_xor_b32 v3, s62, v3
  v_lshlrev_b32 v3, 4, v3
  v_lshl_add_u32 v2, v2, 7, v3
  v_lshrrev_b32 v3, 5, v0
  v_lshl_add_u32 v2, v3, 3, v2
  v_add_u32 v2, 147456, v2
  s_waitcnt lgkmcnt(14)
  ds_read_b64 v[240:241], v2
  v_xor_b32 v3, 16, v2
  s_waitcnt lgkmcnt(14)
  ds_read_b64 v[242:243], v3
  v_xor_b32 v3, 32, v2
  s_waitcnt lgkmcnt(14)
  ds_read_b64 v[244:245], v3
  v_xor_b32 v3, 48, v2
  s_waitcnt lgkmcnt(14)
  ds_read_b64 v[246:247], v3
  s_waitcnt lgkmcnt(0)
  s_barrier
  s_lshl_b32 s63, s57, 4
  v_mov_b32 v9, s63
  s_waitcnt vmcnt(2)
  v_readfirstlane_b32 s62, v190
  s_and_b32 s63, s62, 0xff
  s_cmp_ge_u32 s63, 16
  s_cbranch_scc1 mok_12_87c0
  s_mov_b32 s66, 262144
ml_13_87c0:
  global_load_dword v10, v9, s[22:23] sc1
  s_sub_u32 s66, s66, 1
  s_waitcnt vmcnt(0)
  v_readfirstlane_b32 s62, v10
  s_cmp_eq_u32 s66, 0
  s_cbranch_scc1 mok_12_87c0
  s_and_b32 s63, s62, 0xff
  s_cmp_lt_u32 s63, 16
  s_cbranch_scc1 ml_13_87c0
mok_12_87c0:
  s_bfe_u32 s63, s62, 0x80008
  s_mul_i32 s63, s63, s63
  s_bfe_u32 s62, s62, 0xc0010
  s_lshl_b32 s62, s62, 4
  s_cmp_eq_u32 s62, s63
  s_cselect_b32 s89, 1, 0
  s_waitcnt vmcnt(0)
  s_mov_b64 s[64:65], exec
  s_mov_b64 exec, 1
  v_mov_b32 v9, 161792
  v_mov_b32 v10, 1
  ds_add_rtn_u32 v9, v9, v10
  s_waitcnt lgkmcnt(0)
  v_readfirstlane_b32 s62, v9
  s_cmp_lg_u32 s62, 3
  s_cbranch_scc1 sig_14_87c0
  s_cmp_eq_u32 s89, 0
  s_cbranch_scc1 sigg_15_87c0
  s_lshl_b32 s62, s59, 7
  s_lshl_b32 s63, s60, 2
  s_add_u32 s62, s62, s63
  s_add_u32 s62, s62, 12091392
  v_mov_b32 v9, s62
  global_store_dword v9, v10, s[24:25]
  s_branch sig_14_87c0
sigg_15_87c0:
  s_lshl_b32 s62, s59, 8
  s_add_u32 s62, s62, 12058624
  v_mov_b32 v9, s62
  global_atomic_add v9, v10, s[24:25]
sig_14_87c0:
  s_mov_b64 exec, s[64:65]
  s_lshr_b32 s62, s56, 1
  s_lshl_b32 s62, s62, 15
  v_lshrrev_b32 v2, 5, v0
  v_bfe_u32 v3, v0, 2, 2
  v_lshl_add_u32 v2, v2, 2, v3
  v_lshlrev_b32 v2, 7, v2
  v_lshrrev_b32 v3, 1, v3
  v_lshl_add_u32 v2, v3, 6, v2
  v_bfe_u32 v3, v0, 4, 1
  v_lshl_add_u32 v2, v3, 5, v2
  v_and_b32 v3, 3, v0
  v_lshl_add_u32 v2, v3, 3, v2
  v_add_u32 v2, s62, v2
  v_add_u32 v2, 65536, v2
  v_mov_b32 v14, v2
  v_xor_b32 v15, 64, v2
  s_and_b32 s63, s56, 1
  s_lshl_b32 s62, s63, 6
  v_xor_b32 v14, s62, v14
  v_mov_b32 v200, 0x3f803f80
  v_mov_b32 v201, 0x3f803f80
  v_mov_b32 v202, 0x3f803f80
  v_mov_b32 v203, 0x3f803f80
  ds_read_b64_tr_b16 v[144:145], v14 offset:0
  ds_read_b64_tr_b16 v[146:147], v14 offset:1024
  ds_read_b64_tr_b16 v[148:149], v14 offset:2048
  ds_read_b64_tr_b16 v[150:151], v14 offset:3072
  ds_read_b64_tr_b16 v[152:153], v14 offset:4096
  ds_read_b64_tr_b16 v[154:155], v14 offset:5120
  ds_read_b64_tr_b16 v[156:157], v14 offset:6144
  ds_read_b64_tr_b16 v[158:159], v14 offset:7168
  ds_read_b64_tr_b16 v[160:161], v14 offset:8192
  ds_read_b64_tr_b16 v[162:163], v14 offset:9216
  ds_read_b64_tr_b16 v[164:165], v14 offset:10240
  ds_read_b64_tr_b16 v[166:167], v14 offset:11264
  s_waitcnt lgkmcnt(10)
  v_mfma_f32_32x32x16_bf16 v[168:183], v[144:147], v[200:203], 0
  ds_read_b64_tr_b16 v[144:145], v14 offset:12288
  ds_read_b64_tr_b16 v[146:147], v14 offset:13312
  s_waitcnt lgkmcnt(10)
  v_mfma_f32_32x32x16_bf16 v[184:199], v[148:151], v[200:203], 0
  ds_read_b64_tr_b16 v[148:149], v14 offset:14336
  ds_read_b64_tr_b16 v[150:151], v14 offset:15360
  s_waitcnt lgkmcnt(10)
  v_mfma_f32_32x32x16_bf16 v[168:183], v[152:155], v[200:203], v[168:183]
  ds_read_b64_tr_b16 v[152:153], v14 offset:16384
  ds_read_b64_tr_b16 v[154:155], v14 offset:17408
  s_waitcnt lgkmcnt(10)
  v_mfma_f32_32x32x16_bf16 v[184:199], v[156:159], v[200:203], v[184:199]
  ds_read_b64_tr_b16 v[156:157], v14 offset:18432
  ds_read_b64_tr_b16 v[158:159], v14 offset:19456
  s_waitcnt lgkmcnt(10)
  v_mfma_f32_32x32x16_bf16 v[168:183], v[160:163], v[200:203], v[168:183]
  ds_read_b64_tr_b16 v[160:161], v14 offset:20480
  ds_read_b64_tr_b16 v[162:163], v14 offset:21504
  s_waitcnt lgkmcnt(10)
  v_mfma_f32_32x32x16_bf16 v[184:199], v[164:167], v[200:203], v[184:199]
  ds_read_b64_tr_b16 v[164:165], v14 offset:22528
  ds_read_b64_tr_b16 v[166:167], v14 offset:23552
  s_waitcnt lgkmcnt(10)
  v_mfma_f32_32x32x16_bf16 v[168:183], v[144:147], v[200:203], v[168:183]
  ds_read_b64_tr_b16 v[144:145], v14 offset:24576
  ds_read_b64_tr_b16 v[146:147], v14 offset:25600
  s_waitcnt lgkmcnt(10)
  v_mfma_f32_32x32x16_bf16 v[184:199], v[148:151], v[200:203], v[184:199]
  ds_read_b64_tr_b16 v[148:149], v14 offset:26624
  ds_read_b64_tr_b16 v[150:151], v14 offset:27648
  s_waitcnt lgkmcnt(10)
  v_mfma_f32_32x32x16_bf16 v[168:183], v[152:155], v[200:203], v[168:183]
  ds_read_b64_tr_b16 v[152:153], v14 offset:28672
  ds_read_b64_tr_b16 v[154:155], v14 offset:29696
  s_waitcnt lgkmcnt(10)
  v_mfma_f32_32x32x16_bf16 v[184:199], v[156:159], v[200:203], v[184:199]
  ds_read_b64_tr_b16 v[156:157], v14 offset:30720
  ds_read_b64_tr_b16 v[158:159], v14 offset:31744
  s_waitcnt lgkmcnt(10)
  v_mfma_f32_32x32x16_bf16 v[168:183], v[160:163], v[200:203], v[168:183]
  s_waitcnt lgkmcnt(8)
  v_mfma_f32_32x32x16_bf16 v[184:199], v[164:167], v[200:203], v[184:199]
  s_waitcnt lgkmcnt(6)
  v_mfma_f32_32x32x16_bf16 v[168:183], v[144:147], v[200:203], v[168:183]
  s_waitcnt lgkmcnt(4)
  v_mfma_f32_32x32x16_bf16 v[184:199], v[148:151], v[200:203], v[184:199]
  s_waitcnt lgkmcnt(2)
  v_mfma_f32_32x32x16_bf16 v[168:183], v[152:155], v[200:203], v[168:183]
  s_waitcnt lgkmcnt(0)
  v_mfma_f32_32x32x16_bf16 v[184:199], v[156:159], v[200:203], v[184:199]
  s_and_b32 s63, s56, 1
  s_add_u32 s63, s63, 0
  s_lshl_b32 s63, s63, 7
  s_add_u32 s63, s63, 160768
  v_lshrrev_b32 v15, 5, v0
  v_lshlrev_b32 v15, 4, v15
  v_add_u32 v15, s63, v15
  s_nop 4
  v_add_f32 v168, v168, v184
  v_add_f32 v169, v169, v185
  v_add_f32 v170, v170, v186
  v_add_f32 v171, v171, v187
  v_add_f32 v172, v172, v188
  v_add_f32 v173, v173, v189
  v_add_f32 v174, v174, v190
  v_add_f32 v175, v175, v191
  v_add_f32 v176, v176, v192
  v_add_f32 v177, v177, v193
  v_add_f32 v178, v178, v194
  v_add_f32 v179, v179, v195
  v_add_f32 v180, v180, v196
  v_add_f32 v181, v181, v197
  v_add_f32 v182, v182, v198
  v_add_f32 v183, v183, v199
  s_mov_b32 exec_lo, 1
  s_mov_b32 exec_hi, 1
  ds_add_f32 v15, v168 offset:0
  ds_add_f32 v15, v169 offset:4
  ds_add_f32 v15, v170 offset:8
  ds_add_f32 v15, v171 offset:12
  ds_add_f32 v15, v172 offset:32
  ds_add_f32 v15, v173 offset:36
  ds_add_f32 v15, v174 offset:40
  ds_add_f32 v15, v175 offset:44
  ds_add_f32 v15, v176 offset:64
  ds_add_f32 v15, v177 offset:68
  ds_add_f32 v15, v178 offset:72
  ds_add_f32 v15, v179 offset:76
  ds_add_f32 v15, v180 offset:96
  ds_add_f32 v15, v181 offset:100
  ds_add_f32 v15, v182 offset:104
  s_waitcnt lgkmcnt(14)
  ds_add_f32 v15, v183 offset:108
  s_mov_b64 exec, -1
  s_lshl_b32 s92, s59, 1
  s_add_u32 s92, s92, s90
  s_lshl_b32 s92, s92, 15
  s_lshl_b32 s63, s91, 14
  s_add_u32 s92, s92, s63
  s_cmp_lg_u32 s89, 0
  s_cbranch_scc1 me_18_87c0
  s_cmp_lg_u32 s56, 0
  s_cbranch_scc1 wo_16_87c0
me_18_87c0:
  s_cmp_eq_u32 s89, 0
  s_cbranch_scc1 pg_19_87c0
  s_lshl_b32 s62, s59, 7
  s_add_u32 s62, s62, 12091392
  v_and_b32 v9, 15, v0
  v_lshl_add_u32 v9, v9, 2, s62
  s_mov_b32 s66, 262144
  s_mov_b64 exec, 0xff
pl_21_87c0:
  global_load_dword v10, v9, s[24:25] sc1
  s_sub_u32 s66, s66, 1
  s_waitcnt vmcnt(0)
  v_cmp_ne_u32 vcc, 1, v10
  s_cmp_eq_u32 s66, 0
  s_cbranch_scc1 pl_21_87c0x
  s_nop 3
  s_cbranch_vccnz pl_21_87c0
pl_21_87c0x:
  s_mov_b64 exec, -1
  s_branch pe_20_87c0
pg_19_87c0:
  s_lshl_b32 s62, s59, 8
  s_add_u32 s62, s62, 12058624
  v_mov_b32 v9, s62
  s_mov_b32 s66, 262144
poll_22_87c0:
  global_load_dword v10, v9, s[24:25] sc1
  s_sub_u32 s66, s66, 1
  s_waitcnt vmcnt(0)
  v_readfirstlane_b32 s62, v10
  s_cmp_eq_u32 s66, 0
  s_cbranch_scc1 pdone_23_87c0
  s_cmp_ge_u32 s62, 8
  s_cbranch_scc1 pdone_23_87c0
  s_sleep 1
  s_branch poll_22_87c0
pdone_23_87c0:
pe_20_87c0:
  v_mov_b32 v9, 161808
  v_mov_b32 v10, 1
  s_waitcnt lgkmcnt(14)
  ds_write_b32 v9, v10
  s_waitcnt lgkmcnt(0)
  s_branch wd_17_87c0
wo_16_87c0:
  v_mov_b32 v9, 161808
  s_mov_b32 s66, 2097152
lp_24_87c0:
  s_waitcnt lgkmcnt(14)
  ds_read_b32 v10, v9
  s_sub_u32 s66, s66, 1
  s_waitcnt lgkmcnt(0)
  v_readfirstlane_b32 s62, v10
  s_cmp_eq_u32 s66, 0
  s_cbranch_scc1 wd_17_87c0
  s_cmp_eq_u32 s62, 0
  s_cbranch_scc1 lp_24_87c0
wd_17_87c0:
  buffer_load_dwordx4 v[144:147], v1, s[48:51], s92 offen offset:0 sc1
  buffer_load_dwordx4 v[148:151], v1, s[48:51], s92 offen offset:1024 sc1
  buffer_load_dwordx4 v[152:155], v1, s[48:51], s92 offen offset:2048 sc1
  buffer_load_dwordx4 v[156:159], v1, s[48:51], s92 offen offset:3072 sc1
  s_add_u32 s92, s92, 4096
  buffer_load_dwordx4 v[160:163], v1, s[48:51], s92 offen offset:0 sc1
  buffer_load_dwordx4 v[164:167], v1, s[48:51], s92 offen offset:1024 sc1
  buffer_load_dwordx4 v[168:171], v1, s[48:51], s92 offen offset:2048 sc1
  buffer_load_dwordx4 v[172:175], v1, s[48:51], s92 offen offset:3072 sc1
  s_waitcnt vmcnt(7)
  v_mfma_f32_32x32x16_bf16 v[208:223], v[16:19], v[144:147], 0
  v_mfma_f32_32x32x16_bf16 v[224:239], v[20:23], v[144:147], 0
  s_add_u32 s92, s92, 4096
  buffer_load_dwordx4 v[176:179], v1, s[48:51], s92 offen offset:0 sc1
  s_waitcnt vmcnt(7)
  v_mfma_f32_32x32x16_bf16 v[208:223], v[24:27], v[148:151], v[208:223]
  v_mfma_f32_32x32x16_bf16 v[224:239], v[28:31], v[148:151], v[224:239]
  buffer_load_dwordx4 v[180:183], v1, s[48:51], s92 offen offset:1024 sc1
  s_waitcnt vmcnt(7)
  v_mfma_f32_32x32x16_bf16 v[208:223], v[32:35], v[152:155], v[208:223]
  v_mfma_f32_32x32x16_bf16 v[224:239], v[36:39], v[152:155], v[224:239]
  buffer_load_dwordx4 v[184:187], v1, s[48:51], s92 offen offset:2048 sc1
  s_waitcnt vmcnt(7)
  v_mfma_f32_32x32x16_bf16 v[208:223], v[40:43], v[156:159], v[208:223]
  v_mfma_f32_32x32x16_bf16 v[224:239], v[44:47], v[156:159], v[224:239]
  buffer_load_dwordx4 v[188:191], v1, s[48:51], s92 offen offset:3072 sc1
  s_waitcnt vmcnt(7)
  v_mfma_f32_32x32x16_bf16 v[208:223], v[48:51], v[160:163], v[208:223]
  v_mfma_f32_32x32x16_bf16 v[224:239], v[52:55], v[160:163], v[224:239]
  s_add_u32 s92, s92, 4096
  buffer_load_dwordx4 v[192:195], v1, s[48:51], s92 offen offset:0 sc1
  s_waitcnt vmcnt(7)
  v_mfma_f32_32x32x16_bf16 v[208:223], v[56:59], v[164:167], v[208:223]
  v_mfma_f32_32x32x16_bf16 v[224:239], v[60:63], v[164:167], v[224:239]
  buffer_load_dwordx4 v[196:199], v1, s[48:51], s92 offen offset:1024 sc1
  s_waitcnt vmcnt(7)
  v_mfma_f32_32x32x16_bf16 v[208:223], v[64:67], v[168:171], v[208:223]
  v_mfma_f32_32x32x16_bf16 v[224:239], v[68:71], v[168:171], v[224:239]
  buffer_load_dwordx4 v[200:203], v1, s[48:51], s92 offen offset:2048 sc1
  s_waitcnt vmcnt(7)
  v_mfma_f32_32x32x16_bf16 v[208:223], v[72:75], v[172:175], v[208:223]
  v_mfma_f32_32x32x16_bf16 v[224:239], v[76:79], v[172:175], v[224:239]
  buffer_load_dwordx4 v[204:207], v1, s[48:51], s92 offen offset:3072 sc1
  s_waitcnt vmcnt(7)
  v_mfma_f32_32x32x16_bf16 v[208:223], v[80:83], v[176:179], v[208:223]
  v_mfma_f32_32x32x16_bf16 v[224:239], v[84:87], v[176:179], v[224:239]
  s_waitcnt vmcnt(6)
  v_mfma_f32_32x32x16_bf16 v[208:223], v[88:91], v[180:183], v[208:223]
  v_mfma_f32_32x32x16_bf16 v[224:239], v[92:95], v[180:183], v[224:239]
  s_waitcnt vmcnt(5)
  v_mfma_f32_32x32x16_bf16 v[208:223], v[96:99], v[184:187], v[208:223]
  v_mfma_f32_32x32x16_bf16 v[224:239], v[100:103], v[184:187], v[224:239]
  s_waitcnt vmcnt(4)
  v_mfma_f32_32x32x16_bf16 v[208:223], v[104:107], v[188:191], v[208:223]
  v_mfma_f32_32x32x16_bf16 v[224:239], v[108:111], v[188:191], v[224:239]
  s_waitcnt vmcnt(3)
  v_mfma_f32_32x32x16_bf16 v[208:223], v[112:115], v[192:195], v[208:223]
  v_mfma_f32_32x32x16_bf16 v[224:239], v[116:119], v[192:195], v[224:239]
  s_waitcnt vmcnt(2)
  v_mfma_f32_32x32x16_bf16 v[208:223], v[120:123], v[196:199], v[208:223]
  v_mfma_f32_32x32x16_bf16 v[224:239], v[124:127], v[196:199], v[224:239]
  s_waitcnt vmcnt(1)
  v_mfma_f32_32x32x16_bf16 v[208:223], v[128:131], v[200:203], v[208:223]
  v_mfma_f32_32x32x16_bf16 v[224:239], v[132:135], v[200:203], v[224:239]
  s_waitcnt vmcnt(0)
  v_mfma_f32_32x32x16_bf16 v[208:223], v[136:139], v[204:207], v[208:223]
  v_mfma_f32_32x32x16_bf16 v[224:239], v[140:143], v[204:207], v[224:239]
  s_lshl_b32 s62, s56, 12
  s_add_u32 s62, s62, 131072
  v_add_u32 v2, s62, v1
  v_xor_b32 v3, 4096, v2
  v_lshlrev_b32 v48, 16, v240
  v_and_b32 v49, 0xffff0000, v240
  v_lshlrev_b32 v50, 16, v241
  v_and_b32 v51, 0xffff0000, v241
  v_lshlrev_b32 v52, 16, v242
  v_and_b32 v53, 0xffff0000, v242
  v_lshlrev_b32 v54, 16, v243
  v_and_b32 v55, 0xffff0000, v243
  v_lshlrev_b32 v56, 16, v244
  v_and_b32 v57, 0xffff0000, v244
  v_lshlrev_b32 v58, 16, v245
  v_and_b32 v59, 0xffff0000, v245
  v_lshlrev_b32 v60, 16, v246
  v_and_b32 v61, 0xffff0000, v246
  v_lshlrev_b32 v62, 16, v247
  v_and_b32 v63, 0xffff0000, v247
  ds_write_b128 v2, v[224:227] offset:0
  ds_write_b128 v2, v[228:231] offset:1024
  ds_write_b128 v2, v[232:235] offset:2048
  ds_write_b128 v2, v[236:239] offset:3072
  v_add_f32 v208, v208, v48
  v_add_f32 v209, v209, v49
  v_add_f32 v210, v210, v50
  v_add_f32 v211, v211, v51
  v_add_f32 v212, v212, v52
  v_add_f32 v213, v213, v53
  v_add_f32 v214, v214, v54
  v_add_f32 v215, v215, v55
  v_add_f32 v216, v216, v56
  v_add_f32 v217, v217, v57
  v_add_f32 v218, v218, v58
  v_add_f32 v219, v219, v59
  v_add_f32 v220, v220, v60
  v_add_f32 v221, v221, v61
  v_add_f32 v222, v222, v62
  v_add_f32 v223, v223, v63
  s_lshl_b32 s62, s59, 1
  s_add_u32 s62, s62, s90
  s_lshl_b32 s93, s62, 12
  s_lshl_b32 s92, s62, 15
  s_lshl_b32 s63, s60, 1
  s_add_u32 s63, s63, s91
  s_lshl_b32 s65, s63, 8
  s_add_u32 s93, s93, s65
  s_add_u32 s93, s93, 11534336
  s_lshl_b32 s63, s63, 11
  s_add_u32 s92, s92, s63
  s_add_u32 s92, s92, 2097152
  v_lshlrev_b32 v12, 3, v0
  s_waitcnt lgkmcnt(0)
  s_barrier
  ds_read_b128 v[32:35], v3 offset:0
  ds_read_b128 v[36:39], v3 offset:1024
  ds_read_b128 v[40:43], v3 offset:2048
  ds_read_b128 v[44:47], v3 offset:3072
  s_waitcnt lgkmcnt(3)
  v_add_f32 v208, v208, v32
  v_add_f32 v209, v209, v33
  v_add_f32 v210, v210, v34
  v_add_f32 v211, v211, v35
  s_waitcnt lgkmcnt(2)
  v_add_f32 v212, v212, v36
  v_add_f32 v213, v213, v37
  v_add_f32 v214, v214, v38
  v_add_f32 v215, v215, v39
  s_waitcnt lgkmcnt(1)
  v_add_f32 v216, v216, v40
  v_add_f32 v217, v217, v41
  v_add_f32 v218, v218, v42
  v_add_f32 v219, v219, v43
  s_waitcnt lgkmcnt(0)
  v_add_f32 v220, v220, v44
  v_add_f32 v221, v221, v45
  v_add_f32 v222, v222, v46
  v_add_f32 v223, v223, v47
  v_cvt_pk_bf16_f32 v248, v208, v209
  v_cvt_pk_bf16_f32 v249, v210, v211
  v_cvt_pk_bf16_f32 v250, v212, v213
  v_cvt_pk_bf16_f32 v251, v214, v215
  v_cvt_pk_bf16_f32 v252, v216, v217
  v_cvt_pk_bf16_f32 v253, v218, v219
  v_cvt_pk_bf16_f32 v254, v220, v221
  v_cvt_pk_bf16_f32 v255, v222, v223
  buffer_store_dwordx4 v[248:251], v1, s[48:51], s92 offen sc1
  buffer_store_dwordx4 v[252:255], v1, s[48:51], s92 offen offset:1024 sc1
  v_add_f32 v64, v208, v209
  v_add_f32 v66, v210, v211
  v_mul_f32 v65, v208, v208
  v_mul_f32 v67, v209, v209
  v_fmac_f32 v65, v210, v210
  v_fmac_f32 v67, v211, v211
  v_add_f32 v64, v64, v212
  v_add_f32 v66, v66, v213
  v_fmac_f32 v65, v212, v212
  v_fmac_f32 v67, v213, v213
  v_add_f32 v64, v64, v214
  v_add_f32 v66, v66, v215
  v_fmac_f32 v65, v214, v214
  v_fmac_f32 v67, v215, v215
  v_add_f32 v64, v64, v216
  v_add_f32 v66, v66, v217
  v_fmac_f32 v65, v216, v216
  v_fmac_f32 v67, v217, v217
  v_add_f32 v64, v64, v218
  v_add_f32 v66, v66, v219
  v_fmac_f32 v65, v218, v218
  v_fmac_f32 v67, v219, v219
  v_add_f32 v64, v64, v220
  v_add_f32 v66, v66, v221
  v_fmac_f32 v65, v220, v220
  v_fmac_f32 v67, v221, v221
  v_add_f32 v64, v64, v222
  v_add_f32 v66, v66, v223
  v_fmac_f32 v65, v222, v222
  v_fmac_f32 v67, v223, v223
  v_add_f32 v64, v64, v66
  v_add_f32 v65, v65, v67
  v_mov_b32 v66, v64
  v_mov_b32 v67, v65
  s_nop 0
  v_permlane32_swap_b32 v64, v66
  v_permlane32_swap_b32 v65, v67
  v_add_f32 v64, v64, v66
  v_add_f32 v65, v65, v67
  s_mov_b32 exec_hi, 0
  buffer_store_dwordx2 v[64:65], v12, s[48:51], s93 offen sc1
  s_mov_b32 exec_hi, -1
  v_lshrrev_b32 v2, 5, v0
  v_bfe_u32 v3, v0, 2, 2
  v_lshl_add_u32 v2, v2, 2, v3
  v_lshlrev_b32 v2, 7, v2
  v_lshrrev_b32 v3, 1, v3
  v_lshl_add_u32 v2, v3, 6, v2
  v_bfe_u32 v3, v0, 4, 1
  v_lshl_add_u32 v2, v3, 5, v2
  v_and_b32 v3, 3, v0
  v_lshl_add_u32 v2, v3, 3, v2
  v_add_u32 v2, 65536, v2
  v_mov_b32 v4, v2
  v_xor_b32 v5, 64, v2
  v_add_u32 v6, 4294901760, v4
  v_add_u32 v7, 4294901760, v5
  v_lshrrev_b32 v8, 5, v0
  v_lshlrev_b32 v8, 4, v8
  v_add_u32 v8, 159744, v8
  s_barrier
  s_cmp_ge_u32 s58, 14
  s_cbranch_scc1 p3skip_25_87c0
  s_lshl_b32 s62, s58, 7
  s_lshl_b32 s63, s56, 5
  s_add_u32 s62, s62, s63
  s_lshl_b32 s62, s62, 1
  v_lshlrev_b32 v2, 2, v0
  v_add_u32 v2, s62, v2
  s_mov_b64 exec, 0xffff
  global_load_dword v9, v2, s[14:15]
  s_mov_b64 exec, -1
  s_lshr_b32 s62, s56, 1
  s_lshl_b32 s62, s62, 15
  v_lshrrev_b32 v2, 5, v0
  v_bfe_u32 v3, v0, 2, 2
  v_lshl_add_u32 v2, v2, 2, v3
  v_lshlrev_b32 v2, 7, v2
  v_lshrrev_b32 v3, 1, v3
  v_lshl_add_u32 v2, v3, 6, v2
  v_bfe_u32 v3, v0, 4, 1
  v_lshl_add_u32 v2, v3, 5, v2
  v_and_b32 v3, 3, v0
  v_lshl_add_u32 v2, v3, 3, v2
  v_add_u32 v2, s62, v2
  v_mov_b32 v14, v2
  v_xor_b32 v15, 64, v2
  s_and_b32 s63, s56, 1
  s_lshl_b32 s62, s63, 6
  v_xor_b32 v14, s62, v14
  v_mov_b32 v176, 0x3f803f80
  v_mov_b32 v177, 0x3f803f80
  v_mov_b32 v178, 0x3f803f80
  v_mov_b32 v179, 0x3f803f80
  ds_read_b64_tr_b16 v[16:17], v14 offset:0
  ds_read_b64_tr_b16 v[18:19], v14 offset:1024
  ds_read_b64_tr_b16 v[20:21], v14 offset:2048
  ds_read_b64_tr_b16 v[22:23], v14 offset:3072
  ds_read_b64_tr_b16 v[24:25], v14 offset:4096
  ds_read_b64_tr_b16 v[26:27], v14 offset:5120
  ds_read_b64_tr_b16 v[28:29], v14 offset:6144
  ds_read_b64_tr_b16 v[30:31], v14 offset:7168
  ds_read_b64_tr_b16 v[32:33], v14 offset:8192
  ds_read_b64_tr_b16 v[34:35], v14 offset:9216
  ds_read_b64_tr_b16 v[36:37], v14 offset:10240
  ds_read_b64_tr_b16 v[38:39], v14 offset:11264
  s_waitcnt lgkmcnt(10)
  v_mfma_f32_32x32x16_bf16 v[144:159], v[16:19], v[176:179], 0
  ds_read_b64_tr_b16 v[16:17], v14 offset:12288
  ds_read_b64_tr_b16 v[18:19], v14 offset:13312
  s_waitcnt lgkmcnt(10)
  v_mfma_f32_32x32x16_bf16 v[160:175], v[20:23], v[176:179], 0
  ds_read_b64_tr_b16 v[20:21], v14 offset:14336
  ds_read_b64_tr_b16 v[22:23], v14 offset:15360
  s_waitcnt lgkmcnt(10)
  v_mfma_f32_32x32x16_bf16 v[144:159], v[24:27], v[176:179], v[144:159]
  ds_read_b64_tr_b16 v[24:25], v14 offset:16384
  ds_read_b64_tr_b16 v[26:27], v14 offset:17408
  s_waitcnt lgkmcnt(10)
  v_mfma_f32_32x32x16_bf16 v[160:175], v[28:31], v[176:179], v[160:175]
  ds_read_b64_tr_b16 v[28:29], v14 offset:18432
  ds_read_b64_tr_b16 v[30:31], v14 offset:19456
  s_waitcnt lgkmcnt(10)
  v_mfma_f32_32x32x16_bf16 v[144:159], v[32:35], v[176:179], v[144:159]
  ds_read_b64_tr_b16 v[32:33], v14 offset:20480
  ds_read_b64_tr_b16 v[34:35], v14 offset:21504
  s_waitcnt lgkmcnt(10)
  v_mfma_f32_32x32x16_bf16 v[160:175], v[36:39], v[176:179], v[160:175]
  ds_read_b64_tr_b16 v[36:37], v14 offset:22528
  ds_read_b64_tr_b16 v[38:39], v14 offset:23552
  s_waitcnt lgkmcnt(10)
  v_mfma_f32_32x32x16_bf16 v[144:159], v[16:19], v[176:179], v[144:159]
  ds_read_b64_tr_b16 v[16:17], v14 offset:24576
  ds_read_b64_tr_b16 v[18:19], v14 offset:25600
  s_waitcnt lgkmcnt(10)
  v_mfma_f32_32x32x16_bf16 v[160:175], v[20:23], v[176:179], v[160:175]
  ds_read_b64_tr_b16 v[20:21], v14 offset:26624
  ds_read_b64_tr_b16 v[22:23], v14 offset:27648
  s_waitcnt lgkmcnt(10)
  v_mfma_f32_32x32x16_bf16 v[144:159], v[24:27], v[176:179], v[144:159]
  ds_read_b64_tr_b16 v[24:25], v14 offset:28672
  ds_read_b64_tr_b16 v[26:27], v14 offset:29696
  s_waitcnt lgkmcnt(10)
  v_mfma_f32_32x32x16_bf16 v[160:175], v[28:31], v[176:179], v[160:175]
  ds_read_b64_tr_b16 v[28:29], v14 offset:30720
  ds_read_b64_tr_b16 v[30:31], v14 offset:31744
  s_waitcnt lgkmcnt(10)
  v_mfma_f32_32x32x16_bf16 v[144:159], v[32:35], v[176:179], v[144:159]
  s_waitcnt lgkmcnt(8)
  v_mfma_f32_32x32x16_bf16 v[160:175], v[36:39], v[176:179], v[160:175]
  s_waitcnt lgkmcnt(6)
  v_mfma_f32_32x32x16_bf16 v[144:159], v[16:19], v[176:179], v[144:159]
  s_add_u32 s92, s57, 32
  s_waitcnt vmcnt(0)
  s_mov_b64 s[64:65], exec
  s_mov_b64 exec, 1
  v_mov_b32 v2, 161796
  v_mov_b32 v3, 1
  ds_add_rtn_u32 v2, v2, v3
  s_waitcnt lgkmcnt(0)
  v_readfirstlane_b32 s62, v2
  s_cmp_lg_u32 s62, 3
  s_cbranch_scc1 sig_27_87c0
  s_cmp_eq_u32 s89, 0
  s_cbranch_scc1 sigg_28_87c0
  s_lshl_b32 s62, s92, 7
  s_lshl_b32 s63, s58, 2
  s_add_u32 s62, s62, s63
  s_add_u32 s62, s62, 12091392
  v_mov_b32 v2, s62
  global_store_dword v2, v3, s[24:25]
  s_branch sig_27_87c0
sigg_28_87c0:
  s_lshl_b32 s62, s92, 8
  s_add_u32 s62, s62, 12058624
  v_mov_b32 v2, s62
  global_atomic_add v2, v3, s[24:25]
sig_27_87c0:
  s_mov_b64 exec, s[64:65]
  v_mfma_f32_32x32x16_bf16 v[160:175], v[20:23], v[176:179], v[160:175]
  v_mfma_f32_32x32x16_bf16 v[144:159], v[24:27], v[176:179], v[144:159]
  v_mfma_f32_32x32x16_bf16 v[160:175], v[28:31], v[176:179], v[160:175]
  s_and_b32 s63, s56, 1
  s_add_u32 s63, s63, 2
  s_lshl_b32 s63, s63, 7
  s_add_u32 s63, s63, 160768
  v_lshrrev_b32 v15, 5, v0
  v_lshlrev_b32 v15, 4, v15
  v_add_u32 v15, s63, v15
  s_nop 4
  v_add_f32 v144, v144, v160
  v_add_f32 v145, v145, v161
  v_add_f32 v146, v146, v162
  v_add_f32 v147, v147, v163
  v_add_f32 v148, v148, v164
  v_add_f32 v149, v149, v165
  v_add_f32 v150, v150, v166
  v_add_f32 v151, v151, v167
  v_add_f32 v152, v152, v168
  v_add_f32 v153, v153, v169
  v_add_f32 v154, v154, v170
  v_add_f32 v155, v155, v171
  v_add_f32 v156, v156, v172
  v_add_f32 v157, v157, v173
  v_add_f32 v158, v158, v174
  v_add_f32 v159, v159, v175
  s_mov_b32 exec_lo, 1
  s_mov_b32 exec_hi, 1
  ds_add_f32 v15, v144 offset:0
  ds_add_f32 v15, v145 offset:4
  ds_add_f32 v15, v146 offset:8
  ds_add_f32 v15, v147 offset:12
  ds_add_f32 v15, v148 offset:32
  ds_add_f32 v15, v149 offset:36
  ds_add_f32 v15, v150 offset:40
  ds_add_f32 v15, v151 offset:44
  ds_add_f32 v15, v152 offset:64
  ds_add_f32 v15, v153 offset:68
  ds_add_f32 v15, v154 offset:72
  ds_add_f32 v15, v155 offset:76
  ds_add_f32 v15, v156 offset:96
  ds_add_f32 v15, v157 offset:100
  ds_add_f32 v15, v158 offset:104
  s_waitcnt lgkmcnt(14)
  ds_add_f32 v15, v159 offset:108
  s_mov_b64 exec, -1
  s_mov_b64 exec, 0xffff
  v_lshlrev_b32 v2, 16, v9
  v_and_b32 v3, 0xffff0000, v9
  s_lshl_b32 s62, s56, 7
  s_add_u32 s62, s62, 161280
  v_lshl_add_u32 v10, v0, 3, s62
  s_waitcnt lgkmcnt(14)
  ds_write_b64 v10, v[2:3]
  s_mov_b64 exec, -1
  s_waitcnt lgkmcnt(0)
  s_barrier
  s_lshl_b32 s90, s57, 2
  s_add_u32 s90, s90, s56
  s_lshl_b32 s93, s90, 12
  s_add_u32 s93, s93, 11534336
  s_lshl_b32 s91, s90, 15
  s_add_u32 s91, s91, 2097152
  s_mul_i32 s94, s90, 114688
  s_lshl_b32 s62, s58, 13
  s_add_u32 s94, s94, s62
  s_add_u32 s94, s94, 4194304
  v_and_b32 v2, 31, v0
  v_lshlrev_b32 v2, 3, v2
  v_lshrrev_b32 v3, 5, v0
  v_lshl_add_u32 v12, v3, 8, v2
  s_add_u32 s92, s57, 32
  ds_read_b64_tr_b16 v[208:209], v4 offset:0
  ds_read_b64_tr_b16 v[210:211], v4 offset:1024
  ds_read_b64_tr_b16 v[212:213], v5 offset:0
  ds_read_b64_tr_b16 v[214:215], v5 offset:1024
  ds_read_b64_tr_b16 v[216:217], v6 offset:0
  ds_read_b64_tr_b16 v[218:219], v6 offset:1024
  ds_read_b64_tr_b16 v[220:221], v7 offset:0
  ds_read_b64_tr_b16 v[222:223], v7 offset:1024
  s_cmp_lg_u32 s89, 0
  s_cbranch_scc1 me_31_87c0
  s_cmp_lg_u32 s56, 0
  s_cbranch_scc1 wo_29_87c0
me_31_87c0:
  s_cmp_eq_u32 s89, 0
  s_cbranch_scc1 pg_32_87c0
  s_lshl_b32 s62, s92, 7
  s_add_u32 s62, s62, 12091392
  v_and_b32 v9, 15, v0
  v_lshl_add_u32 v9, v9, 2, s62
  s_mov_b32 s66, 262144
  s_mov_b64 exec, 0xffff
pl_34_87c0:
  global_load_dword v10, v9, s[24:25] sc1
  s_sub_u32 s66, s66, 1
  s_waitcnt vmcnt(0)
  v_cmp_ne_u32 vcc, 1, v10
  s_cmp_eq_u32 s66, 0
  s_cbranch_scc1 pl_34_87c0x
  s_nop 3
  s_cbranch_vccnz pl_34_87c0
pl_34_87c0x:
  s_mov_b64 exec, -1
  s_branch pe_33_87c0
pg_32_87c0:
  s_lshl_b32 s62, s92, 8
  s_add_u32 s62, s62, 12058624
  v_mov_b32 v9, s62
  s_mov_b32 s66, 262144
poll_35_87c0:
  global_load_dword v10, v9, s[24:25] sc1
  s_sub_u32 s66, s66, 1
  s_waitcnt vmcnt(0)
  v_readfirstlane_b32 s62, v10
  s_cmp_eq_u32 s66, 0
  s_cbranch_scc1 pdone_36_87c0
  s_cmp_ge_u32 s62, 16
  s_cbranch_scc1 pdone_36_87c0
  s_sleep 1
  s_branch poll_35_87c0
pdone_36_87c0:
pe_33_87c0:
  v_mov_b32 v9, 161812
  v_mov_b32 v10, 1
  ds_write_b32 v9, v10
  s_waitcnt lgkmcnt(0)
  s_branch wd_30_87c0
wo_29_87c0:
  v_mov_b32 v9, 161812
  s_mov_b32 s66, 2097152
lp_37_87c0:
  ds_read_b32 v10, v9
  s_sub_u32 s66, s66, 1
  s_waitcnt lgkmcnt(0)
  v_readfirstlane_b32 s62, v10
  s_cmp_eq_u32 s66, 0
  s_cbranch_scc1 wd_30_87c0
  s_cmp_eq_u32 s62, 0
  s_cbranch_scc1 lp_37_87c0
wd_30_87c0:
  buffer_load_dwordx4 v[16:19], v1, s[48:51], s91 offen offset:0 sc1
  buffer_load_dwordx4 v[20:23], v1, s[48:51], s91 offen offset:1024 sc1
  buffer_load_dwordx4 v[24:27], v1, s[48:51], s91 offen offset:2048 sc1
  buffer_load_dwordx4 v[28:31], v1, s[48:51], s91 offen offset:3072 sc1
  s_add_u32 s91, s91, 4096
  buffer_load_dwordx4 v[32:35], v1, s[48:51], s91 offen offset:0 sc1
  buffer_load_dwordx4 v[36:39], v1, s[48:51], s91 offen offset:1024 sc1
  buffer_load_dwordx4 v[40:43], v1, s[48:51], s91 offen offset:2048 sc1
  buffer_load_dwordx4 v[44:47], v1, s[48:51], s91 offen offset:3072 sc1
  s_waitcnt vmcnt(7)
  v_mfma_f32_32x32x16_bf16 v[144:159], v[208:211], v[16:19], 0
  s_add_u32 s91, s91, 4096
  buffer_load_dwordx4 v[48:51], v1, s[48:51], s91 offen offset:0 sc1
  v_mfma_f32_32x32x16_bf16 v[160:175], v[212:215], v[16:19], 0
  ds_read_b64_tr_b16 v[224:225], v4 offset:2048
  ds_read_b64_tr_b16 v[226:227], v4 offset:3072
  ds_read_b64_tr_b16 v[228:229], v5 offset:2048
  v_mfma_f32_32x32x16_bf16 v[176:191], v[216:219], v[16:19], 0
  ds_read_b64_tr_b16 v[230:231], v5 offset:3072
  ds_read_b64_tr_b16 v[232:233], v6 offset:2048
  v_mfma_f32_32x32x16_bf16 v[192:207], v[220:223], v[16:19], 0
  ds_read_b64_tr_b16 v[234:235], v6 offset:3072
  ds_read_b64_tr_b16 v[236:237], v7 offset:2048
  ds_read_b64_tr_b16 v[238:239], v7 offset:3072
  s_waitcnt vmcnt(7) lgkmcnt(6)
  v_mfma_f32_32x32x16_bf16 v[144:159], v[224:227], v[20:23], v[144:159]
  buffer_load_dwordx4 v[52:55], v1, s[48:51], s91 offen offset:1024 sc1
  ds_read_b64_tr_b16 v[208:209], v4 offset:4096
  s_waitcnt lgkmcnt(5)
  v_mfma_f32_32x32x16_bf16 v[160:175], v[228:231], v[20:23], v[160:175]
  ds_read_b64_tr_b16 v[210:211], v4 offset:5120
  ds_read_b64_tr_b16 v[212:213], v5 offset:4096
  s_waitcnt lgkmcnt(5)
  v_mfma_f32_32x32x16_bf16 v[176:191], v[232:235], v[20:23], v[176:191]
  ds_read_b64_tr_b16 v[214:215], v5 offset:5120
  ds_read_b64_tr_b16 v[216:217], v6 offset:4096
  s_waitcnt lgkmcnt(5)
  v_mfma_f32_32x32x16_bf16 v[192:207], v[236:239], v[20:23], v[192:207]
  ds_read_b64_tr_b16 v[218:219], v6 offset:5120
  ds_read_b64_tr_b16 v[220:221], v7 offset:4096
  ds_read_b64_tr_b16 v[222:223], v7 offset:5120
  s_waitcnt vmcnt(7) lgkmcnt(6)
  v_mfma_f32_32x32x16_bf16 v[144:159], v[208:211], v[24:27], v[144:159]
  buffer_load_dwordx4 v[56:59], v1, s[48:51], s91 offen offset:2048 sc1
  ds_read_b64_tr_b16 v[224:225], v4 offset:6144
  s_waitcnt lgkmcnt(5)
  v_mfma_f32_32x32x16_bf16 v[160:175], v[212:215], v[24:27], v[160:175]
  ds_read_b64_tr_b16 v[226:227], v4 offset:7168
  ds_read_b64_tr_b16 v[228:229], v5 offset:6144
  s_waitcnt lgkmcnt(5)
  v_mfma_f32_32x32x16_bf16 v[176:191], v[216:219], v[24:27], v[176:191]
  ds_read_b64_tr_b16 v[230:231], v5 offset:7168
  ds_read_b64_tr_b16 v[232:233], v6 offset:6144
  s_waitcnt lgkmcnt(5)
  v_mfma_f32_32x32x16_bf16 v[192:207], v[220:223], v[24:27], v[192:207]
  ds_read_b64_tr_b16 v[234:235], v6 offset:7168
  ds_read_b64_tr_b16 v[236:237], v7 offset:6144
  ds_read_b64_tr_b16 v[238:239], v7 offset:7168
  s_waitcnt vmcnt(7) lgkmcnt(6)
  v_mfma_f32_32x32x16_bf16 v[144:159], v[224:227], v[28:31], v[144:159]
  buffer_load_dwordx4 v[60:63], v1, s[48:51], s91 offen offset:3072 sc1
  ds_read_b64_tr_b16 v[208:209], v4 offset:8192
  s_waitcnt lgkmcnt(5)
  v_mfma_f32_32x32x16_bf16 v[160:175], v[228:231], v[28:31], v[160:175]
  ds_read_b64_tr_b16 v[210:211], v4 offset:9216
  ds_read_b64_tr_b16 v[212:213], v5 offset:8192
  s_waitcnt lgkmcnt(5)
  v_mfma_f32_32x32x16_bf16 v[176:191], v[232:235], v[28:31], v[176:191]
  ds_read_b64_tr_b16 v[214:215], v5 offset:9216
  ds_read_b64_tr_b16 v[216:217], v6 offset:8192
  s_waitcnt lgkmcnt(5)
  v_mfma_f32_32x32x16_bf16 v[192:207], v[236:239], v[28:31], v[192:207]
  ds_read_b64_tr_b16 v[218:219], v6 offset:9216
  ds_read_b64_tr_b16 v[220:221], v7 offset:8192
  ds_read_b64_tr_b16 v[222:223], v7 offset:9216
  s_waitcnt vmcnt(7) lgkmcnt(6)
  v_mfma_f32_32x32x16_bf16 v[144:159], v[208:211], v[32:35], v[144:159]
  s_add_u32 s91, s91, 4096
  buffer_load_dwordx4 v[64:67], v1, s[48:51], s91 offen offset:0 sc1
  s_waitcnt lgkmcnt(4)
  v_mfma_f32_32x32x16_bf16 v[160:175], v[212:215], v[32:35], v[160:175]
  ds_read_b64_tr_b16 v[224:225], v4 offset:10240
  ds_read_b64_tr_b16 v[226:227], v4 offset:11264
  ds_read_b64_tr_b16 v[228:229], v5 offset:10240
  s_waitcnt lgkmcnt(5)
  v_mfma_f32_32x32x16_bf16 v[176:191], v[216:219], v[32:35], v[176:191]
  ds_read_b64_tr_b16 v[230:231], v5 offset:11264
  ds_read_b64_tr_b16 v[232:233], v6 offset:10240
  s_waitcnt lgkmcnt(5)
  v_mfma_f32_32x32x16_bf16 v[192:207], v[220:223], v[32:35], v[192:207]
  ds_read_b64_tr_b16 v[234:235], v6 offset:11264
  ds_read_b64_tr_b16 v[236:237], v7 offset:10240
  ds_read_b64_tr_b16 v[238:239], v7 offset:11264
  s_waitcnt vmcnt(7) lgkmcnt(6)
  v_mfma_f32_32x32x16_bf16 v[144:159], v[224:227], v[36:39], v[144:159]
  buffer_load_dwordx4 v[68:71], v1, s[48:51], s91 offen offset:1024 sc1
  ds_read_b64_tr_b16 v[208:209], v4 offset:12288
  s_waitcnt lgkmcnt(5)
  v_mfma_f32_32x32x16_bf16 v[160:175], v[228:231], v[36:39], v[160:175]
  ds_read_b64_tr_b16 v[210:211], v4 offset:13312
  ds_read_b64_tr_b16 v[212:213], v5 offset:12288
  s_waitcnt lgkmcnt(5)
  v_mfma_f32_32x32x16_bf16 v[176:191], v[232:235], v[36:39], v[176:191]
  ds_read_b64_tr_b16 v[214:215], v5 offset:13312
  ds_read_b64_tr_b16 v[216:217], v6 offset:12288
  s_waitcnt lgkmcnt(5)
  v_mfma_f32_32x32x16_bf16 v[192:207], v[236:239], v[36:39], v[192:207]
  ds_read_b64_tr_b16 v[218:219], v6 offset:13312
  ds_read_b64_tr_b16 v[220:221], v7 offset:12288
  ds_read_b64_tr_b16 v[222:223], v7 offset:13312
  s_waitcnt vmcnt(7) lgkmcnt(6)
  v_mfma_f32_32x32x16_bf16 v[144:159], v[208:211], v[40:43], v[144:159]
  buffer_load_dwordx4 v[72:75], v1, s[48:51], s91 offen offset:2048 sc1
  ds_read_b64_tr_b16 v[224:225], v4 offset:14336
  s_waitcnt lgkmcnt(5)
  v_mfma_f32_32x32x16_bf16 v[160:175], v[212:215], v[40:43], v[160:175]
  ds_read_b64_tr_b16 v[226:227], v4 offset:15360
  ds_read_b64_tr_b16 v[228:229], v5 offset:14336
  s_waitcnt lgkmcnt(5)
  v_mfma_f32_32x32x16_bf16 v[176:191], v[216:219], v[40:43], v[176:191]
  ds_read_b64_tr_b16 v[230:231], v5 offset:15360
  ds_read_b64_tr_b16 v[232:233], v6 offset:14336
  s_waitcnt lgkmcnt(5)
  v_mfma_f32_32x32x16_bf16 v[192:207], v[220:223], v[40:43], v[192:207]
  ds_read_b64_tr_b16 v[234:235], v6 offset:15360
  ds_read_b64_tr_b16 v[236:237], v7 offset:14336
  ds_read_b64_tr_b16 v[238:239], v7 offset:15360
  s_waitcnt vmcnt(7) lgkmcnt(6)
  v_mfma_f32_32x32x16_bf16 v[144:159], v[224:227], v[44:47], v[144:159]
  buffer_load_dwordx4 v[76:79], v1, s[48:51], s91 offen offset:3072 sc1
  ds_read_b64_tr_b16 v[208:209], v4 offset:16384
  s_waitcnt lgkmcnt(5)
  v_mfma_f32_32x32x16_bf16 v[160:175], v[228:231], v[44:47], v[160:175]
  ds_read_b64_tr_b16 v[210:211], v4 offset:17408
  ds_read_b64_tr_b16 v[212:213], v5 offset:16384
  s_waitcnt lgkmcnt(5)
  v_mfma_f32_32x32x16_bf16 v[176:191], v[232:235], v[44:47], v[176:191]
  ds_read_b64_tr_b16 v[214:215], v5 offset:17408
  ds_read_b64_tr_b16 v[216:217], v6 offset:16384
  s_waitcnt lgkmcnt(5)
  v_mfma_f32_32x32x16_bf16 v[192:207], v[236:239], v[44:47], v[192:207]
  ds_read_b64_tr_b16 v[218:219], v6 offset:17408
  ds_read_b64_tr_b16 v[220:221], v7 offset:16384
  ds_read_b64_tr_b16 v[222:223], v7 offset:17408
  s_waitcnt vmcnt(7) lgkmcnt(6)
  v_mfma_f32_32x32x16_bf16 v[144:159], v[208:211], v[48:51], v[144:159]
  s_add_u32 s91, s91, 4096
  buffer_load_dwordx4 v[80:83], v1, s[48:51], s91 offen offset:0 sc1
  ds_read_b64_tr_b16 v[224:225], v4 offset:18432
  ds_read_b64_tr_b16 v[226:227], v4 offset:19456
  s_waitcnt lgkmcnt(6)
  v_mfma_f32_32x32x16_bf16 v[160:175], v[212:215], v[48:51], v[160:175]
  ds_read_b64_tr_b16 v[228:229], v5 offset:18432
  ds_read_b64_tr_b16 v[230:231], v5 offset:19456
  ds_read_b64_tr_b16 v[232:233], v6 offset:18432
  ds_read_b64_tr_b16 v[234:235], v6 offset:19456
  ds_read_b64_tr_b16 v[236:237], v7 offset:18432
  s_waitcnt lgkmcnt(9)
  v_mfma_f32_32x32x16_bf16 v[176:191], v[216:219], v[48:51], v[176:191]
  ds_read_b64_tr_b16 v[238:239], v7 offset:19456
  buffer_load_dwordx2 v[16:17], v12, s[48:51], s93 offen offset:0 sc1
  buffer_load_dwordx2 v[18:19], v12, s[48:51], s93 offen offset:512 sc1
  buffer_load_dwordx2 v[20:21], v12, s[48:51], s93 offen offset:1024 sc1
  s_waitcnt lgkmcnt(8)
  v_mfma_f32_32x32x16_bf16 v[192:207], v[220:223], v[48:51], v[192:207]
  buffer_load_dwordx2 v[22:23], v12, s[48:51], s93 offen offset:1536 sc1
  buffer_load_dwordx2 v[24:25], v12, s[48:51], s93 offen offset:2048 sc1
  buffer_load_dwordx2 v[26:27], v12, s[48:51], s93 offen offset:2560 sc1
  buffer_load_dwordx2 v[28:29], v12, s[48:51], s93 offen offset:3072 sc1
  buffer_load_dwordx2 v[30:31], v12, s[48:51], s93 offen offset:3584 sc1
  s_waitcnt vmcnt(15) lgkmcnt(6)
  v_mfma_f32_32x32x16_bf16 v[144:159], v[224:227], v[52:55], v[144:159]
  buffer_load_dwordx4 v[84:87], v1, s[48:51], s91 offen offset:1024 sc1
  ds_read_b64_tr_b16 v[208:209], v4 offset:20480
  s_waitcnt lgkmcnt(5)
  v_mfma_f32_32x32x16_bf16 v[160:175], v[228:231], v[52:55], v[160:175]
  ds_read_b64_tr_b16 v[210:211], v4 offset:21504
  ds_read_b64_tr_b16 v[212:213], v5 offset:20480
  s_waitcnt lgkmcnt(5)
  v_mfma_f32_32x32x16_bf16 v[176:191], v[232:235], v[52:55], v[176:191]
  ds_read_b64_tr_b16 v[214:215], v5 offset:21504
  ds_read_b64_tr_b16 v[216:217], v6 offset:20480
  s_waitcnt lgkmcnt(5)
  v_mfma_f32_32x32x16_bf16 v[192:207], v[236:239], v[52:55], v[192:207]
  ds_read_b64_tr_b16 v[218:219], v6 offset:21504
  ds_read_b64_tr_b16 v[220:221], v7 offset:20480
  ds_read_b64_tr_b16 v[222:223], v7 offset:21504
  s_waitcnt vmcnt(15) lgkmcnt(6)
  v_mfma_f32_32x32x16_bf16 v[144:159], v[208:211], v[56:59], v[144:159]
  buffer_load_dwordx4 v[88:91], v1, s[48:51], s91 offen offset:2048 sc1
  ds_read_b64_tr_b16 v[224:225], v4 offset:22528
  s_waitcnt lgkmcnt(5)
  v_mfma_f32_32x32x16_bf16 v[160:175], v[212:215], v[56:59], v[160:175]
  ds_read_b64_tr_b16 v[226:227], v4 offset:23552
  ds_read_b64_tr_b16 v[228:229], v5 offset:22528
  s_waitcnt lgkmcnt(5)
  v_mfma_f32_32x32x16_bf16 v[176:191], v[216:219], v[56:59], v[176:191]
  ds_read_b64_tr_b16 v[230:231], v5 offset:23552
  ds_read_b64_tr_b16 v[232:233], v6 offset:22528
  s_waitcnt lgkmcnt(5)
  v_mfma_f32_32x32x16_bf16 v[192:207], v[220:223], v[56:59], v[192:207]
  ds_read_b64_tr_b16 v[234:235], v6 offset:23552
  ds_read_b64_tr_b16 v[236:237], v7 offset:22528
  ds_read_b64_tr_b16 v[238:239], v7 offset:23552
  s_waitcnt vmcnt(15) lgkmcnt(6)
  v_mfma_f32_32x32x16_bf16 v[144:159], v[224:227], v[60:63], v[144:159]
  buffer_load_dwordx4 v[92:95], v1, s[48:51], s91 offen offset:3072 sc1
  ds_read_b64_tr_b16 v[208:209], v4 offset:24576
  s_waitcnt lgkmcnt(5)
  v_mfma_f32_32x32x16_bf16 v[160:175], v[228:231], v[60:63], v[160:175]
  ds_read_b64_tr_b16 v[210:211], v4 offset:25600
  ds_read_b64_tr_b16 v[212:213], v5 offset:24576
  s_waitcnt lgkmcnt(5)
  v_mfma_f32_32x32x16_bf16 v[176:191], v[232:235], v[60:63], v[176:191]
  ds_read_b64_tr_b16 v[214:215], v5 offset:25600
  ds_read_b64_tr_b16 v[216:217], v6 offset:24576
  s_waitcnt lgkmcnt(5)
  v_mfma_f32_32x32x16_bf16 v[192:207], v[236:239], v[60:63], v[192:207]
  ds_read_b64_tr_b16 v[218:219], v6 offset:25600
  ds_read_b64_tr_b16 v[220:221], v7 offset:24576
  ds_read_b64_tr_b16 v[222:223], v7 offset:25600
  s_waitcnt vmcnt(15) lgkmcnt(6)
  v_mfma_f32_32x32x16_bf16 v[144:159], v[208:211], v[64:67], v[144:159]
  s_add_u32 s91, s91, 4096
  buffer_load_dwordx4 v[96:99], v1, s[48:51], s91 offen offset:0 sc1
  s_waitcnt lgkmcnt(4)
  v_mfma_f32_32x32x16_bf16 v[160:175], v[212:215], v[64:67], v[160:175]
  ds_read_b64_tr_b16 v[224:225], v4 offset:26624
  ds_read_b64_tr_b16 v[226:227], v4 offset:27648
  ds_read_b64_tr_b16 v[228:229], v5 offset:26624
  s_waitcnt lgkmcnt(5)
  v_mfma_f32_32x32x16_bf16 v[176:191], v[216:219], v[64:67], v[176:191]
  ds_read_b64_tr_b16 v[230:231], v5 offset:27648
  ds_read_b64_tr_b16 v[232:233], v6 offset:26624
  s_waitcnt lgkmcnt(5)
  v_mfma_f32_32x32x16_bf16 v[192:207], v[220:223], v[64:67], v[192:207]
  ds_read_b64_tr_b16 v[234:235], v6 offset:27648
  ds_read_b64_tr_b16 v[236:237], v7 offset:26624
  ds_read_b64_tr_b16 v[238:239], v7 offset:27648
  s_waitcnt vmcnt(15) lgkmcnt(6)
  v_mfma_f32_32x32x16_bf16 v[144:159], v[224:227], v[68:71], v[144:159]
  buffer_load_dwordx4 v[100:103], v1, s[48:51], s91 offen offset:1024 sc1
  ds_read_b64_tr_b16 v[208:209], v4 offset:28672
  s_waitcnt lgkmcnt(5)
  v_mfma_f32_32x32x16_bf16 v[160:175], v[228:231], v[68:71], v[160:175]
  ds_read_b64_tr_b16 v[210:211], v4 offset:29696
  ds_read_b64_tr_b16 v[212:213], v5 offset:28672
  s_waitcnt lgkmcnt(5)
  v_mfma_f32_32x32x16_bf16 v[176:191], v[232:235], v[68:71], v[176:191]
  ds_read_b64_tr_b16 v[214:215], v5 offset:29696
  ds_read_b64_tr_b16 v[216:217], v6 offset:28672
  s_waitcnt lgkmcnt(5)
  v_mfma_f32_32x32x16_bf16 v[192:207], v[236:239], v[68:71], v[192:207]
  ds_read_b64_tr_b16 v[218:219], v6 offset:29696
  ds_read_b64_tr_b16 v[220:221], v7 offset:28672
  ds_read_b64_tr_b16 v[222:223], v7 offset:29696
  s_waitcnt vmcnt(15) lgkmcnt(6)
  v_mfma_f32_32x32x16_bf16 v[144:159], v[208:211], v[72:75], v[144:159]
  buffer_load_dwordx4 v[104:107], v1, s[48:51], s91 offen offset:2048 sc1
  ds_read_b64_tr_b16 v[224:225], v4 offset:30720
  s_waitcnt lgkmcnt(5)
  v_mfma_f32_32x32x16_bf16 v[160:175], v[212:215], v[72:75], v[160:175]
  ds_read_b64_tr_b16 v[226:227], v4 offset:31744
  ds_read_b64_tr_b16 v[228:229], v5 offset:30720
  s_waitcnt lgkmcnt(5)
  v_mfma_f32_32x32x16_bf16 v[176:191], v[216:219], v[72:75], v[176:191]
  ds_read_b64_tr_b16 v[230:231], v5 offset:31744
  ds_read_b64_tr_b16 v[232:233], v6 offset:30720
  s_waitcnt lgkmcnt(5)
  v_mfma_f32_32x32x16_bf16 v[192:207], v[220:223], v[72:75], v[192:207]
  ds_read_b64_tr_b16 v[234:235], v6 offset:31744
  ds_read_b64_tr_b16 v[236:237], v7 offset:30720
  ds_read_b64_tr_b16 v[238:239], v7 offset:31744
  s_waitcnt vmcnt(15) lgkmcnt(6)
  v_mfma_f32_32x32x16_bf16 v[144:159], v[224:227], v[76:79], v[144:159]
  buffer_load_dwordx4 v[108:111], v1, s[48:51], s91 offen offset:3072 sc1
  ds_read_b64_tr_b16 v[208:209], v4 offset:32768
  s_waitcnt lgkmcnt(5)
  v_mfma_f32_32x32x16_bf16 v[160:175], v[228:231], v[76:79], v[160:175]
  ds_read_b64_tr_b16 v[210:211], v4 offset:33792
  ds_read_b64_tr_b16 v[212:213], v5 offset:32768
  s_waitcnt lgkmcnt(5)
  v_mfma_f32_32x32x16_bf16 v[176:191], v[232:235], v[76:79], v[176:191]
  ds_read_b64_tr_b16 v[214:215], v5 offset:33792
  ds_read_b64_tr_b16 v[216:217], v6 offset:32768
  s_waitcnt lgkmcnt(5)
  v_mfma_f32_32x32x16_bf16 v[192:207], v[236:239], v[76:79], v[192:207]
  ds_read_b64_tr_b16 v[218:219], v6 offset:33792
  ds_read_b64_tr_b16 v[220:221], v7 offset:32768
  ds_read_b64_tr_b16 v[222:223], v7 offset:33792
  s_waitcnt vmcnt(15) lgkmcnt(6)
  v_mfma_f32_32x32x16_bf16 v[144:159], v[208:211], v[80:83], v[144:159]
  s_add_u32 s91, s91, 4096
  buffer_load_dwordx4 v[112:115], v1, s[48:51], s91 offen offset:0 sc1
  s_waitcnt lgkmcnt(4)
  v_mfma_f32_32x32x16_bf16 v[160:175], v[212:215], v[80:83], v[160:175]
  ds_read_b64_tr_b16 v[224:225], v4 offset:34816
  ds_read_b64_tr_b16 v[226:227], v4 offset:35840
  ds_read_b64_tr_b16 v[228:229], v5 offset:34816
  s_waitcnt lgkmcnt(5)
  v_mfma_f32_32x32x16_bf16 v[176:191], v[216:219], v[80:83], v[176:191]
  ds_read_b64_tr_b16 v[230:231], v5 offset:35840
  ds_read_b64_tr_b16 v[232:233], v6 offset:34816
  s_waitcnt lgkmcnt(5)
  v_mfma_f32_32x32x16_bf16 v[192:207], v[220:223], v[80:83], v[192:207]
  ds_read_b64_tr_b16 v[234:235], v6 offset:35840
  ds_read_b64_tr_b16 v[236:237], v7 offset:34816
  ds_read_b64_tr_b16 v[238:239], v7 offset:35840
  s_waitcnt vmcnt(7) lgkmcnt(6)
  v_mfma_f32_32x32x16_bf16 v[144:159], v[224:227], v[84:87], v[144:159]
  buffer_load_dwordx4 v[116:119], v1, s[48:51], s91 offen offset:1024 sc1
  ds_read_b64_tr_b16 v[208:209], v4 offset:36864
  s_waitcnt lgkmcnt(5)
  v_mfma_f32_32x32x16_bf16 v[160:175], v[228:231], v[84:87], v[160:175]
  ds_read_b64_tr_b16 v[210:211], v4 offset:37888
  ds_read_b64_tr_b16 v[212:213], v5 offset:36864
  s_waitcnt lgkmcnt(5)
  v_mfma_f32_32x32x16_bf16 v[176:191], v[232:235], v[84:87], v[176:191]
  ds_read_b64_tr_b16 v[214:215], v5 offset:37888
  ds_read_b64_tr_b16 v[216:217], v6 offset:36864
  s_waitcnt lgkmcnt(5)
  v_mfma_f32_32x32x16_bf16 v[192:207], v[236:239], v[84:87], v[192:207]
  ds_read_b64_tr_b16 v[218:219], v6 offset:37888
  ds_read_b64_tr_b16 v[220:221], v7 offset:36864
  ds_read_b64_tr_b16 v[222:223], v7 offset:37888
  s_waitcnt vmcnt(7) lgkmcnt(6)
  v_mfma_f32_32x32x16_bf16 v[144:159], v[208:211], v[88:91], v[144:159]
  buffer_load_dwordx4 v[120:123], v1, s[48:51], s91 offen offset:2048 sc1
  ds_read_b64_tr_b16 v[224:225], v4 offset:38912
  s_waitcnt lgkmcnt(5)
  v_mfma_f32_32x32x16_bf16 v[160:175], v[212:215], v[88:91], v[160:175]
  ds_read_b64_tr_b16 v[226:227], v4 offset:39936
  ds_read_b64_tr_b16 v[228:229], v5 offset:38912
  s_waitcnt lgkmcnt(5)
  v_mfma_f32_32x32x16_bf16 v[176:191], v[216:219], v[88:91], v[176:191]
  ds_read_b64_tr_b16 v[230:231], v5 offset:39936
  ds_read_b64_tr_b16 v[232:233], v6 offset:38912
  s_waitcnt lgkmcnt(5)
  v_mfma_f32_32x32x16_bf16 v[192:207], v[220:223], v[88:91], v[192:207]
  ds_read_b64_tr_b16 v[234:235], v6 offset:39936
  ds_read_b64_tr_b16 v[236:237], v7 offset:38912
  ds_read_b64_tr_b16 v[238:239], v7 offset:39936
  s_waitcnt vmcnt(7) lgkmcnt(6)
  v_mfma_f32_32x32x16_bf16 v[144:159], v[224:227], v[92:95], v[144:159]
  buffer_load_dwordx4 v[124:127], v1, s[48:51], s91 offen offset:3072 sc1
  ds_read_b64_tr_b16 v[208:209], v4 offset:40960
  s_waitcnt lgkmcnt(5)
  v_mfma_f32_32x32x16_bf16 v[160:175], v[228:231], v[92:95], v[160:175]
  ds_read_b64_tr_b16 v[210:211], v4 offset:41984
  ds_read_b64_tr_b16 v[212:213], v5 offset:40960
  s_waitcnt lgkmcnt(5)
  v_mfma_f32_32x32x16_bf16 v[176:191], v[232:235], v[92:95], v[176:191]
  ds_read_b64_tr_b16 v[214:215], v5 offset:41984
  ds_read_b64_tr_b16 v[216:217], v6 offset:40960
  s_waitcnt lgkmcnt(5)
  v_mfma_f32_32x32x16_bf16 v[192:207], v[236:239], v[92:95], v[192:207]
  ds_read_b64_tr_b16 v[218:219], v6 offset:41984
  ds_read_b64_tr_b16 v[220:221], v7 offset:40960
  ds_read_b64_tr_b16 v[222:223], v7 offset:41984
  s_waitcnt vmcnt(7) lgkmcnt(6)
  v_mfma_f32_32x32x16_bf16 v[144:159], v[208:211], v[96:99], v[144:159]
  s_add_u32 s91, s91, 4096
  buffer_load_dwordx4 v[128:131], v1, s[48:51], s91 offen offset:0 sc1
  s_waitcnt lgkmcnt(4)
  v_mfma_f32_32x32x16_bf16 v[160:175], v[212:215], v[96:99], v[160:175]
  ds_read_b64_tr_b16 v[224:225], v4 offset:43008
  ds_read_b64_tr_b16 v[226:227], v4 offset:44032
  ds_read_b64_tr_b16 v[228:229], v5 offset:43008
  s_waitcnt lgkmcnt(5)
  v_mfma_f32_32x32x16_bf16 v[176:191], v[216:219], v[96:99], v[176:191]
  ds_read_b64_tr_b16 v[230:231], v5 offset:44032
  ds_read_b64_tr_b16 v[232:233], v6 offset:43008
  s_waitcnt lgkmcnt(5)
  v_mfma_f32_32x32x16_bf16 v[192:207], v[220:223], v[96:99], v[192:207]
  ds_read_b64_tr_b16 v[234:235], v6 offset:44032
  ds_read_b64_tr_b16 v[236:237], v7 offset:43008
  ds_read_b64_tr_b16 v[238:239], v7 offset:44032
  s_waitcnt vmcnt(7) lgkmcnt(6)
  v_mfma_f32_32x32x16_bf16 v[144:159], v[224:227], v[100:103], v[144:159]
  buffer_load_dwordx4 v[132:135], v1, s[48:51], s91 offen offset:1024 sc1
  ds_read_b64_tr_b16 v[208:209], v4 offset:45056
  s_waitcnt lgkmcnt(5)
  v_mfma_f32_32x32x16_bf16 v[160:175], v[228:231], v[100:103], v[160:175]
  ds_read_b64_tr_b16 v[210:211], v4 offset:46080
  ds_read_b64_tr_b16 v[212:213], v5 offset:45056
  s_waitcnt lgkmcnt(5)
  v_mfma_f32_32x32x16_bf16 v[176:191], v[232:235], v[100:103], v[176:191]
  ds_read_b64_tr_b16 v[214:215], v5 offset:46080
  ds_read_b64_tr_b16 v[216:217], v6 offset:45056
  s_waitcnt lgkmcnt(5)
  v_mfma_f32_32x32x16_bf16 v[192:207], v[236:239], v[100:103], v[192:207]
  ds_read_b64_tr_b16 v[218:219], v6 offset:46080
  ds_read_b64_tr_b16 v[220:221], v7 offset:45056
  ds_read_b64_tr_b16 v[222:223], v7 offset:46080
  s_waitcnt vmcnt(7) lgkmcnt(6)
  v_mfma_f32_32x32x16_bf16 v[144:159], v[208:211], v[104:107], v[144:159]
  buffer_load_dwordx4 v[136:139], v1, s[48:51], s91 offen offset:2048 sc1
  ds_read_b64_tr_b16 v[224:225], v4 offset:47104
  s_waitcnt lgkmcnt(5)
  v_mfma_f32_32x32x16_bf16 v[160:175], v[212:215], v[104:107], v[160:175]
  ds_read_b64_tr_b16 v[226:227], v4 offset:48128
  ds_read_b64_tr_b16 v[228:229], v5 offset:47104
  s_waitcnt lgkmcnt(5)
  v_mfma_f32_32x32x16_bf16 v[176:191], v[216:219], v[104:107], v[176:191]
  ds_read_b64_tr_b16 v[230:231], v5 offset:48128
  ds_read_b64_tr_b16 v[232:233], v6 offset:47104
  s_waitcnt lgkmcnt(5)
  v_mfma_f32_32x32x16_bf16 v[192:207], v[220:223], v[104:107], v[192:207]
  ds_read_b64_tr_b16 v[234:235], v6 offset:48128
  ds_read_b64_tr_b16 v[236:237], v7 offset:47104
  ds_read_b64_tr_b16 v[238:239], v7 offset:48128
  s_waitcnt vmcnt(7) lgkmcnt(6)
  v_mfma_f32_32x32x16_bf16 v[144:159], v[224:227], v[108:111], v[144:159]
  buffer_load_dwordx4 v[140:143], v1, s[48:51], s91 offen offset:3072 sc1
  ds_read_b64_tr_b16 v[208:209], v4 offset:49152
  s_waitcnt lgkmcnt(5)
  v_mfma_f32_32x32x16_bf16 v[160:175], v[228:231], v[108:111], v[160:175]
  ds_read_b64_tr_b16 v[210:211], v4 offset:50176
  ds_read_b64_tr_b16 v[212:213], v5 offset:49152
  s_waitcnt lgkmcnt(5)
  v_mfma_f32_32x32x16_bf16 v[176:191], v[232:235], v[108:111], v[176:191]
  ds_read_b64_tr_b16 v[214:215], v5 offset:50176
  ds_read_b64_tr_b16 v[216:217], v6 offset:49152
  s_waitcnt lgkmcnt(5)
  v_mfma_f32_32x32x16_bf16 v[192:207], v[236:239], v[108:111], v[192:207]
  ds_read_b64_tr_b16 v[218:219], v6 offset:50176
  ds_read_b64_tr_b16 v[220:221], v7 offset:49152
  ds_read_b64_tr_b16 v[222:223], v7 offset:50176
  s_waitcnt vmcnt(7) lgkmcnt(6)
  v_mfma_f32_32x32x16_bf16 v[144:159], v[208:211], v[112:115], v[144:159]
  ds_read_b64_tr_b16 v[224:225], v4 offset:51200
  ds_read_b64_tr_b16 v[226:227], v4 offset:52224
  s_waitcnt lgkmcnt(6)
  v_mfma_f32_32x32x16_bf16 v[160:175], v[212:215], v[112:115], v[160:175]
  ds_read_b64_tr_b16 v[228:229], v5 offset:51200
  ds_read_b64_tr_b16 v[230:231], v5 offset:52224
  s_waitcnt lgkmcnt(6)
  v_mfma_f32_32x32x16_bf16 v[176:191], v[216:219], v[112:115], v[176:191]
  ds_read_b64_tr_b16 v[232:233], v6 offset:51200
  ds_read_b64_tr_b16 v[234:235], v6 offset:52224
  s_waitcnt lgkmcnt(6)
  v_mfma_f32_32x32x16_bf16 v[192:207], v[220:223], v[112:115], v[192:207]
  ds_read_b64_tr_b16 v[236:237], v7 offset:51200
  ds_read_b64_tr_b16 v[238:239], v7 offset:52224
  s_barrier
  s_waitcnt vmcnt(6) lgkmcnt(6)
  v_mfma_f32_32x32x16_bf16 v[144:159], v[224:227], v[116:119], v[144:159]
  ds_read_b64_tr_b16 v[208:209], v4 offset:53248
  ds_read_b64_tr_b16 v[210:211], v4 offset:54272
  s_waitcnt lgkmcnt(6)
  v_mfma_f32_32x32x16_bf16 v[160:175], v[228:231], v[116:119], v[160:175]
  ds_read_b64_tr_b16 v[212:213], v5 offset:53248
  ds_read_b64_tr_b16 v[214:215], v5 offset:54272
  s_waitcnt lgkmcnt(6)
  v_mfma_f32_32x32x16_bf16 v[176:191], v[232:235], v[116:119], v[176:191]
  ds_read_b64_tr_b16 v[216:217], v6 offset:53248
  ds_read_b64_tr_b16 v[218:219], v6 offset:54272
  s_waitcnt lgkmcnt(6)
  v_mfma_f32_32x32x16_bf16 v[192:207], v[236:239], v[116:119], v[192:207]
  ds_read_b64_tr_b16 v[220:221], v7 offset:53248
  ds_read_b64_tr_b16 v[222:223], v7 offset:54272
  s_waitcnt vmcnt(5) lgkmcnt(6)
  v_mfma_f32_32x32x16_bf16 v[144:159], v[208:211], v[120:123], v[144:159]
  ds_read_b64_tr_b16 v[224:225], v4 offset:55296
  ds_read_b64_tr_b16 v[226:227], v4 offset:56320
  ds_read_b64_tr_b16 v[228:229], v5 offset:55296
  s_waitcnt lgkmcnt(7)
  v_mfma_f32_32x32x16_bf16 v[160:175], v[212:215], v[120:123], v[160:175]
  ds_read_b64_tr_b16 v[230:231], v5 offset:56320
  ds_read_b64_tr_b16 v[232:233], v6 offset:55296
  ds_read_b64_tr_b16 v[234:235], v6 offset:56320
  s_waitcnt lgkmcnt(8)
  v_mfma_f32_32x32x16_bf16 v[176:191], v[216:219], v[120:123], v[176:191]
  ds_read_b64_tr_b16 v[236:237], v7 offset:55296
  ds_read_b64_tr_b16 v[238:239], v7 offset:56320
  v_add_f32 v16, v16, v18
  s_waitcnt lgkmcnt(8)
  v_mfma_f32_32x32x16_bf16 v[192:207], v[220:223], v[120:123], v[192:207]
  v_add_f32 v17, v17, v19
  v_add_f32 v16, v16, v20
  v_add_f32 v17, v17, v21
  v_add_f32 v16, v16, v22
  s_waitcnt vmcnt(4) lgkmcnt(6)
  v_mfma_f32_32x32x16_bf16 v[144:159], v[224:227], v[124:127], v[144:159]
  ds_read_b64_tr_b16 v[208:209], v4 offset:57344
  ds_read_b64_tr_b16 v[210:211], v4 offset:58368
  ds_read_b64_tr_b16 v[212:213], v5 offset:57344
  s_waitcnt lgkmcnt(7)
  v_mfma_f32_32x32x16_bf16 v[160:175], v[228:231], v[124:127], v[160:175]
  ds_read_b64_tr_b16 v[214:215], v5 offset:58368
  ds_read_b64_tr_b16 v[216:217], v6 offset:57344
  ds_read_b64_tr_b16 v[218:219], v6 offset:58368
  ds_read_b64_tr_b16 v[220:221], v7 offset:57344
  s_waitcnt lgkmcnt(9)
  v_mfma_f32_32x32x16_bf16 v[176:191], v[232:235], v[124:127], v[176:191]
  ds_read_b64_tr_b16 v[222:223], v7 offset:58368
  v_add_f32 v17, v17, v23
  v_add_f32 v16, v16, v24
  s_waitcnt lgkmcnt(8)
  v_mfma_f32_32x32x16_bf16 v[192:207], v[236:239], v[124:127], v[192:207]
  v_add_f32 v17, v17, v25
  v_add_f32 v16, v16, v26
  v_add_f32 v17, v17, v27
  v_add_f32 v16, v16, v28
  s_waitcnt vmcnt(3) lgkmcnt(6)
  v_mfma_f32_32x32x16_bf16 v[144:159], v[208:211], v[128:131], v[144:159]
  ds_read_b64_tr_b16 v[224:225], v4 offset:59392
  ds_read_b64_tr_b16 v[226:227], v4 offset:60416
  ds_read_b64_tr_b16 v[228:229], v5 offset:59392
  s_waitcnt lgkmcnt(7)
  v_mfma_f32_32x32x16_bf16 v[160:175], v[212:215], v[128:131], v[160:175]
  ds_read_b64_tr_b16 v[230:231], v5 offset:60416
  ds_read_b64_tr_b16 v[232:233], v6 offset:59392
  ds_read_b64_tr_b16 v[234:235], v6 offset:60416
  ds_read_b64_tr_b16 v[236:237], v7 offset:59392
  s_waitcnt lgkmcnt(9)
  v_mfma_f32_32x32x16_bf16 v[176:191], v[216:219], v[128:131], v[176:191]
  ds_read_b64_tr_b16 v[238:239], v7 offset:60416
  v_add_f32 v17, v17, v29
  v_add_f32 v16, v16, v30
  s_waitcnt lgkmcnt(8)
  v_mfma_f32_32x32x16_bf16 v[192:207], v[220:223], v[128:131], v[192:207]
  v_add_f32 v17, v17, v31
  v_mov_b32 v18, v16
  v_mov_b32 v19, v17
  v_mov_b32 v244, 0xbdd2d3e8
  s_waitcnt vmcnt(2) lgkmcnt(6)
  v_mfma_f32_32x32x16_bf16 v[144:159], v[224:227], v[132:135], v[144:159]
  ds_read_b64_tr_b16 v[208:209], v4 offset:61440
  ds_read_b64_tr_b16 v[210:211], v4 offset:62464
  ds_read_b64_tr_b16 v[212:213], v5 offset:61440
  s_waitcnt lgkmcnt(7)
  v_mfma_f32_32x32x16_bf16 v[160:175], v[228:231], v[132:135], v[160:175]
  ds_read_b64_tr_b16 v[214:215], v5 offset:62464
  ds_read_b64_tr_b16 v[216:217], v6 offset:61440
  ds_read_b64_tr_b16 v[218:219], v6 offset:62464
  ds_read_b64_tr_b16 v[220:221], v7 offset:61440
  s_waitcnt lgkmcnt(9)
  v_mfma_f32_32x32x16_bf16 v[176:191], v[232:235], v[132:135], v[176:191]
  ds_read_b64_tr_b16 v[222:223], v7 offset:62464
  v_mov_b32 v245, 0xc0135761
  v_permlane32_swap_b32 v16, v18
  s_waitcnt lgkmcnt(8)
  v_mfma_f32_32x32x16_bf16 v[192:207], v[236:239], v[132:135], v[192:207]
  v_permlane32_swap_b32 v17, v19
  v_add_f32 v16, v16, v18
  v_add_f32 v17, v17, v19
  v_mul_f32 v16, 0x3b000000, v16
  s_waitcnt vmcnt(1) lgkmcnt(6)
  v_mfma_f32_32x32x16_bf16 v[144:159], v[208:211], v[136:139], v[144:159]
  ds_read_b64_tr_b16 v[224:225], v4 offset:63488
  ds_read_b64_tr_b16 v[226:227], v4 offset:64512
  ds_read_b64_tr_b16 v[228:229], v5 offset:63488
  s_waitcnt lgkmcnt(7)
  v_mfma_f32_32x32x16_bf16 v[160:175], v[212:215], v[136:139], v[160:175]
  ds_read_b64_tr_b16 v[230:231], v5 offset:64512
  ds_read_b64_tr_b16 v[232:233], v6 offset:63488
  ds_read_b64_tr_b16 v[234:235], v6 offset:64512
  ds_read_b64_tr_b16 v[236:237], v7 offset:63488
  s_waitcnt lgkmcnt(9)
  v_mfma_f32_32x32x16_bf16 v[176:191], v[216:219], v[136:139], v[176:191]
  ds_read_b64_tr_b16 v[238:239], v7 offset:64512
  v_mul_f32 v17, 0x3b000000, v17
  v_fma_f32 v17, -v16, v16, v17
  s_waitcnt lgkmcnt(8)
  v_mfma_f32_32x32x16_bf16 v[192:207], v[220:223], v[136:139], v[192:207]
  v_max_f32 v17, 0, v17
  v_add_f32 v17, 0x3727c5ac, v17
  v_rsq_f32 v240, v17
  s_nop 0
  v_mul_f32 v242, v16, v240
  s_waitcnt vmcnt(0) lgkmcnt(6)
  v_mfma_f32_32x32x16_bf16 v[144:159], v[224:227], v[140:143], v[144:159]
  s_waitcnt lgkmcnt(4)
  v_mfma_f32_32x32x16_bf16 v[160:175], v[228:231], v[140:143], v[160:175]
  s_waitcnt lgkmcnt(2)
  v_mfma_f32_32x32x16_bf16 v[176:191], v[232:235], v[140:143], v[176:191]
  s_waitcnt lgkmcnt(0)
  v_mfma_f32_32x32x16_bf16 v[192:207], v[236:239], v[140:143], v[192:207]
  s_barrier
  ds_read_b128 v[64:67], v8 offset:1024
  ds_read_b128 v[68:71], v8 offset:1536
  ds_read_b128 v[72:75], v8 offset:1056
  ds_read_b128 v[76:79], v8 offset:1568
  ds_read_b128 v[80:83], v8 offset:1088
  ds_read_b128 v[84:87], v8 offset:1600
  ds_read_b128 v[88:91], v8 offset:1120
  ds_read_b128 v[92:95], v8 offset:1632
  s_waitcnt lgkmcnt(6)
  v_pk_fma_f32 v[68:69], v[242:243], v[64:65], v[68:69] op_sel_hi:[0,1,1] neg_lo:[1,0,0] neg_hi:[1,0,0]
  v_pk_fma_f32 v[70:71], v[242:243], v[66:67], v[70:71] op_sel_hi:[0,1,1] neg_lo:[1,0,0] neg_hi:[1,0,0]
  s_waitcnt lgkmcnt(4)
  v_pk_fma_f32 v[76:77], v[242:243], v[72:73], v[76:77] op_sel_hi:[0,1,1] neg_lo:[1,0,0] neg_hi:[1,0,0]
  v_pk_fma_f32 v[78:79], v[242:243], v[74:75], v[78:79] op_sel_hi:[0,1,1] neg_lo:[1,0,0] neg_hi:[1,0,0]
  v_pk_fma_f32 v[144:145], v[144:145], v[240:241], v[68:69] op_sel_hi:[1,0,1]
  v_pk_fma_f32 v[146:147], v[146:147], v[240:241], v[70:71] op_sel_hi:[1,0,1]
  v_pk_fma_f32 v[148:149], v[148:149], v[240:241], v[76:77] op_sel_hi:[1,0,1]
  v_pk_fma_f32 v[150:151], v[150:151], v[240:241], v[78:79] op_sel_hi:[1,0,1]
  v_pk_mul_f32 v[32:33], v[144:145], v[144:145]
  v_pk_mul_f32 v[34:35], v[146:147], v[146:147]
  v_pk_mul_f32 v[36:37], v[148:149], v[148:149]
  v_pk_mul_f32 v[38:39], v[150:151], v[150:151]
  v_pk_fma_f32 v[32:33], v[32:33], v[244:245], v[244:245] op_sel:[0,0,1] op_sel_hi:[1,0,1]
  v_pk_fma_f32 v[34:35], v[34:35], v[244:245], v[244:245] op_sel:[0,0,1] op_sel_hi:[1,0,1]
  v_pk_fma_f32 v[36:37], v[36:37], v[244:245], v[244:245] op_sel:[0,0,1] op_sel_hi:[1,0,1]
  v_pk_fma_f32 v[38:39], v[38:39], v[244:245], v[244:245] op_sel:[0,0,1] op_sel_hi:[1,0,1]
  v_pk_mul_f32 v[32:33], v[144:145], v[32:33]
  v_pk_mul_f32 v[34:35], v[146:147], v[34:35]
  v_pk_mul_f32 v[36:37], v[148:149], v[36:37]
  v_pk_mul_f32 v[38:39], v[150:151], v[38:39]
  v_exp_f32 v32, v32
  v_exp_f32 v33, v33
  v_exp_f32 v34, v34
  v_exp_f32 v35, v35
  v_exp_f32 v36, v36
  v_exp_f32 v37, v37
  v_exp_f32 v38, v38
  v_exp_f32 v39, v39
  v_pk_add_f32 v[32:33], v[32:33], 1.0 op_sel_hi:[1,0]
  v_pk_add_f32 v[34:35], v[34:35], 1.0 op_sel_hi:[1,0]
  v_pk_add_f32 v[36:37], v[36:37], 1.0 op_sel_hi:[1,0]
  v_pk_add_f32 v[38:39], v[38:39], 1.0 op_sel_hi:[1,0]
  v_rcp_f32 v32, v32
  v_rcp_f32 v33, v33
  v_rcp_f32 v34, v34
  v_rcp_f32 v35, v35
  v_rcp_f32 v36, v36
  v_rcp_f32 v37, v37
  v_rcp_f32 v38, v38
  v_rcp_f32 v39, v39
  v_pk_mul_f32 v[32:33], v[144:145], v[32:33]
  v_pk_mul_f32 v[34:35], v[146:147], v[34:35]
  v_pk_mul_f32 v[36:37], v[148:149], v[36:37]
  v_pk_mul_f32 v[38:39], v[150:151], v[38:39]
  v_cvt_pk_bf16_f32 v96, v32, v33
  v_cvt_pk_bf16_f32 v97, v34, v35
  v_cvt_pk_bf16_f32 v98, v36, v37
  v_cvt_pk_bf16_f32 v99, v38, v39
  buffer_store_dwordx4 v[96:99], v1, s[48:51], s94 offen offset:0 sc1
  ds_read_b128 v[64:67], v8 offset:1152
  ds_read_b128 v[68:71], v8 offset:1664
  ds_read_b128 v[72:75], v8 offset:1184
  ds_read_b128 v[76:79], v8 offset:1696
  s_waitcnt lgkmcnt(6)
  v_pk_fma_f32 v[84:85], v[242:243], v[80:81], v[84:85] op_sel_hi:[0,1,1] neg_lo:[1,0,0] neg_hi:[1,0,0]
  v_pk_fma_f32 v[86:87], v[242:243], v[82:83], v[86:87] op_sel_hi:[0,1,1] neg_lo:[1,0,0] neg_hi:[1,0,0]
  s_waitcnt lgkmcnt(4)
  v_pk_fma_f32 v[92:93], v[242:243], v[88:89], v[92:93] op_sel_hi:[0,1,1] neg_lo:[1,0,0] neg_hi:[1,0,0]
  v_pk_fma_f32 v[94:95], v[242:243], v[90:91], v[94:95] op_sel_hi:[0,1,1] neg_lo:[1,0,0] neg_hi:[1,0,0]
  v_pk_fma_f32 v[152:153], v[152:153], v[240:241], v[84:85] op_sel_hi:[1,0,1]
  v_pk_fma_f32 v[154:155], v[154:155], v[240:241], v[86:87] op_sel_hi:[1,0,1]
  v_pk_fma_f32 v[156:157], v[156:157], v[240:241], v[92:93] op_sel_hi:[1,0,1]
  v_pk_fma_f32 v[158:159], v[158:159], v[240:241], v[94:95] op_sel_hi:[1,0,1]
  v_pk_mul_f32 v[40:41], v[152:153], v[152:153]
  v_pk_mul_f32 v[42:43], v[154:155], v[154:155]
  v_pk_mul_f32 v[44:45], v[156:157], v[156:157]
  v_pk_mul_f32 v[46:47], v[158:159], v[158:159]
  v_pk_fma_f32 v[40:41], v[40:41], v[244:245], v[244:245] op_sel:[0,0,1] op_sel_hi:[1,0,1]
  v_pk_fma_f32 v[42:43], v[42:43], v[244:245], v[244:245] op_sel:[0,0,1] op_sel_hi:[1,0,1]
  v_pk_fma_f32 v[44:45], v[44:45], v[244:245], v[244:245] op_sel:[0,0,1] op_sel_hi:[1,0,1]
  v_pk_fma_f32 v[46:47], v[46:47], v[244:245], v[244:245] op_sel:[0,0,1] op_sel_hi:[1,0,1]
  v_pk_mul_f32 v[40:41], v[152:153], v[40:41]
  v_pk_mul_f32 v[42:43], v[154:155], v[42:43]
  v_pk_mul_f32 v[44:45], v[156:157], v[44:45]
  v_pk_mul_f32 v[46:47], v[158:159], v[46:47]
  v_exp_f32 v40, v40
  v_exp_f32 v41, v41
  v_exp_f32 v42, v42
  v_exp_f32 v43, v43
  v_exp_f32 v44, v44
  v_exp_f32 v45, v45
  v_exp_f32 v46, v46
  v_exp_f32 v47, v47
  v_pk_add_f32 v[40:41], v[40:41], 1.0 op_sel_hi:[1,0]
  v_pk_add_f32 v[42:43], v[42:43], 1.0 op_sel_hi:[1,0]
  v_pk_add_f32 v[44:45], v[44:45], 1.0 op_sel_hi:[1,0]
  v_pk_add_f32 v[46:47], v[46:47], 1.0 op_sel_hi:[1,0]
  v_rcp_f32 v40, v40
  v_rcp_f32 v41, v41
  v_rcp_f32 v42, v42
  v_rcp_f32 v43, v43
  v_rcp_f32 v44, v44
  v_rcp_f32 v45, v45
  v_rcp_f32 v46, v46
  v_rcp_f32 v47, v47
  v_pk_mul_f32 v[40:41], v[152:153], v[40:41]
  v_pk_mul_f32 v[42:43], v[154:155], v[42:43]
  v_pk_mul_f32 v[44:45], v[156:157], v[44:45]
  v_pk_mul_f32 v[46:47], v[158:159], v[46:47]
  v_cvt_pk_bf16_f32 v100, v40, v41
  v_cvt_pk_bf16_f32 v101, v42, v43
  v_cvt_pk_bf16_f32 v102, v44, v45
  v_cvt_pk_bf16_f32 v103, v46, v47
  buffer_store_dwordx4 v[100:103], v1, s[48:51], s94 offen offset:1024 sc1
  ds_read_b128 v[80:83], v8 offset:1216
  ds_read_b128 v[84:87], v8 offset:1728
  ds_read_b128 v[88:91], v8 offset:1248
  ds_read_b128 v[92:95], v8 offset:1760
  s_waitcnt lgkmcnt(6)
  v_pk_fma_f32 v[68:69], v[242:243], v[64:65], v[68:69] op_sel_hi:[0,1,1] neg_lo:[1,0,0] neg_hi:[1,0,0]
  v_pk_fma_f32 v[70:71], v[242:243], v[66:67], v[70:71] op_sel_hi:[0,1,1] neg_lo:[1,0,0] neg_hi:[1,0,0]
  s_waitcnt lgkmcnt(4)
  v_pk_fma_f32 v[76:77], v[242:243], v[72:73], v[76:77] op_sel_hi:[0,1,1] neg_lo:[1,0,0] neg_hi:[1,0,0]
  v_pk_fma_f32 v[78:79], v[242:243], v[74:75], v[78:79] op_sel_hi:[0,1,1] neg_lo:[1,0,0] neg_hi:[1,0,0]
  v_pk_fma_f32 v[160:161], v[160:161], v[240:241], v[68:69] op_sel_hi:[1,0,1]
  v_pk_fma_f32 v[162:163], v[162:163], v[240:241], v[70:71] op_sel_hi:[1,0,1]
  v_pk_fma_f32 v[164:165], v[164:165], v[240:241], v[76:77] op_sel_hi:[1,0,1]
  v_pk_fma_f32 v[166:167], v[166:167], v[240:241], v[78:79] op_sel_hi:[1,0,1]
  v_pk_mul_f32 v[32:33], v[160:161], v[160:161]
  v_pk_mul_f32 v[34:35], v[162:163], v[162:163]
  v_pk_mul_f32 v[36:37], v[164:165], v[164:165]
  v_pk_mul_f32 v[38:39], v[166:167], v[166:167]
  v_pk_fma_f32 v[32:33], v[32:33], v[244:245], v[244:245] op_sel:[0,0,1] op_sel_hi:[1,0,1]
  v_pk_fma_f32 v[34:35], v[34:35], v[244:245], v[244:245] op_sel:[0,0,1] op_sel_hi:[1,0,1]
  v_pk_fma_f32 v[36:37], v[36:37], v[244:245], v[244:245] op_sel:[0,0,1] op_sel_hi:[1,0,1]
  v_pk_fma_f32 v[38:39], v[38:39], v[244:245], v[244:245] op_sel:[0,0,1] op_sel_hi:[1,0,1]
  v_pk_mul_f32 v[32:33], v[160:161], v[32:33]
  v_pk_mul_f32 v[34:35], v[162:163], v[34:35]
  v_pk_mul_f32 v[36:37], v[164:165], v[36:37]
  v_pk_mul_f32 v[38:39], v[166:167], v[38:39]
  v_exp_f32 v32, v32
  v_exp_f32 v33, v33
  v_exp_f32 v34, v34
  v_exp_f32 v35, v35
  v_exp_f32 v36, v36
  v_exp_f32 v37, v37
  v_exp_f32 v38, v38
  v_exp_f32 v39, v39
  v_pk_add_f32 v[32:33], v[32:33], 1.0 op_sel_hi:[1,0]
  v_pk_add_f32 v[34:35], v[34:35], 1.0 op_sel_hi:[1,0]
  v_pk_add_f32 v[36:37], v[36:37], 1.0 op_sel_hi:[1,0]
  v_pk_add_f32 v[38:39], v[38:39], 1.0 op_sel_hi:[1,0]
  v_rcp_f32 v32, v32
  v_rcp_f32 v33, v33
  v_rcp_f32 v34, v34
  v_rcp_f32 v35, v35
  v_rcp_f32 v36, v36
  v_rcp_f32 v37, v37
  v_rcp_f32 v38, v38
  v_rcp_f32 v39, v39
  v_pk_mul_f32 v[32:33], v[160:161], v[32:33]
  v_pk_mul_f32 v[34:35], v[162:163], v[34:35]
  v_pk_mul_f32 v[36:37], v[164:165], v[36:37]
  v_pk_mul_f32 v[38:39], v[166:167], v[38:39]
  v_cvt_pk_bf16_f32 v96, v32, v33
  v_cvt_pk_bf16_f32 v97, v34, v35
  v_cvt_pk_bf16_f32 v98, v36, v37
  v_cvt_pk_bf16_f32 v99, v38, v39
  buffer_store_dwordx4 v[96:99], v1, s[48:51], s94 offen offset:2048 sc1
  ds_read_b128 v[64:67], v8 offset:1280
  ds_read_b128 v[68:71], v8 offset:1792
  ds_read_b128 v[72:75], v8 offset:1312
  ds_read_b128 v[76:79], v8 offset:1824
  s_waitcnt lgkmcnt(6)
  v_pk_fma_f32 v[84:85], v[242:243], v[80:81], v[84:85] op_sel_hi:[0,1,1] neg_lo:[1,0,0] neg_hi:[1,0,0]
  v_pk_fma_f32 v[86:87], v[242:243], v[82:83], v[86:87] op_sel_hi:[0,1,1] neg_lo:[1,0,0] neg_hi:[1,0,0]
  s_waitcnt lgkmcnt(4)
  v_pk_fma_f32 v[92:93], v[242:243], v[88:89], v[92:93] op_sel_hi:[0,1,1] neg_lo:[1,0,0] neg_hi:[1,0,0]
  v_pk_fma_f32 v[94:95], v[242:243], v[90:91], v[94:95] op_sel_hi:[0,1,1] neg_lo:[1,0,0] neg_hi:[1,0,0]
  v_pk_fma_f32 v[168:169], v[168:169], v[240:241], v[84:85] op_sel_hi:[1,0,1]
  v_pk_fma_f32 v[170:171], v[170:171], v[240:241], v[86:87] op_sel_hi:[1,0,1]
  v_pk_fma_f32 v[172:173], v[172:173], v[240:241], v[92:93] op_sel_hi:[1,0,1]
  v_pk_fma_f32 v[174:175], v[174:175], v[240:241], v[94:95] op_sel_hi:[1,0,1]
  v_pk_mul_f32 v[40:41], v[168:169], v[168:169]
  v_pk_mul_f32 v[42:43], v[170:171], v[170:171]
  v_pk_mul_f32 v[44:45], v[172:173], v[172:173]
  v_pk_mul_f32 v[46:47], v[174:175], v[174:175]
  v_pk_fma_f32 v[40:41], v[40:41], v[244:245], v[244:245] op_sel:[0,0,1] op_sel_hi:[1,0,1]
  v_pk_fma_f32 v[42:43], v[42:43], v[244:245], v[244:245] op_sel:[0,0,1] op_sel_hi:[1,0,1]
  v_pk_fma_f32 v[44:45], v[44:45], v[244:245], v[244:245] op_sel:[0,0,1] op_sel_hi:[1,0,1]
  v_pk_fma_f32 v[46:47], v[46:47], v[244:245], v[244:245] op_sel:[0,0,1] op_sel_hi:[1,0,1]
  v_pk_mul_f32 v[40:41], v[168:169], v[40:41]
  v_pk_mul_f32 v[42:43], v[170:171], v[42:43]
  v_pk_mul_f32 v[44:45], v[172:173], v[44:45]
  v_pk_mul_f32 v[46:47], v[174:175], v[46:47]
  v_exp_f32 v40, v40
  v_exp_f32 v41, v41
  v_exp_f32 v42, v42
  v_exp_f32 v43, v43
  v_exp_f32 v44, v44
  v_exp_f32 v45, v45
  v_exp_f32 v46, v46
  v_exp_f32 v47, v47
  v_pk_add_f32 v[40:41], v[40:41], 1.0 op_sel_hi:[1,0]
  v_pk_add_f32 v[42:43], v[42:43], 1.0 op_sel_hi:[1,0]
  v_pk_add_f32 v[44:45], v[44:45], 1.0 op_sel_hi:[1,0]
  v_pk_add_f32 v[46:47], v[46:47], 1.0 op_sel_hi:[1,0]
  v_rcp_f32 v40, v40
  v_rcp_f32 v41, v41
  v_rcp_f32 v42, v42
  v_rcp_f32 v43, v43
  v_rcp_f32 v44, v44
  v_rcp_f32 v45, v45
  v_rcp_f32 v46, v46
  v_rcp_f32 v47, v47
  v_pk_mul_f32 v[40:41], v[168:169], v[40:41]
  v_pk_mul_f32 v[42:43], v[170:171], v[42:43]
  v_pk_mul_f32 v[44:45], v[172:173], v[44:45]
  v_pk_mul_f32 v[46:47], v[174:175], v[46:47]
  v_cvt_pk_bf16_f32 v100, v40, v41
  v_cvt_pk_bf16_f32 v101, v42, v43
  v_cvt_pk_bf16_f32 v102, v44, v45
  v_cvt_pk_bf16_f32 v103, v46, v47
  buffer_store_dwordx4 v[100:103], v1, s[48:51], s94 offen offset:3072 sc1
  ds_read_b128 v[80:83], v8 offset:1344
  ds_read_b128 v[84:87], v8 offset:1856
  ds_read_b128 v[88:91], v8 offset:1376
  ds_read_b128 v[92:95], v8 offset:1888
  s_waitcnt lgkmcnt(6)
  v_pk_fma_f32 v[68:69], v[242:243], v[64:65], v[68:69] op_sel_hi:[0,1,1] neg_lo:[1,0,0] neg_hi:[1,0,0]
  v_pk_fma_f32 v[70:71], v[242:243], v[66:67], v[70:71] op_sel_hi:[0,1,1] neg_lo:[1,0,0] neg_hi:[1,0,0]
  s_waitcnt lgkmcnt(4)
  v_pk_fma_f32 v[76:77], v[242:243], v[72:73], v[76:77] op_sel_hi:[0,1,1] neg_lo:[1,0,0] neg_hi:[1,0,0]
  v_pk_fma_f32 v[78:79], v[242:243], v[74:75], v[78:79] op_sel_hi:[0,1,1] neg_lo:[1,0,0] neg_hi:[1,0,0]
  v_pk_fma_f32 v[176:177], v[176:177], v[240:241], v[68:69] op_sel_hi:[1,0,1]
  v_pk_fma_f32 v[178:179], v[178:179], v[240:241], v[70:71] op_sel_hi:[1,0,1]
  v_pk_fma_f32 v[180:181], v[180:181], v[240:241], v[76:77] op_sel_hi:[1,0,1]
  v_pk_fma_f32 v[182:183], v[182:183], v[240:241], v[78:79] op_sel_hi:[1,0,1]
  v_pk_mul_f32 v[32:33], v[176:177], v[176:177]
  v_pk_mul_f32 v[34:35], v[178:179], v[178:179]
  v_pk_mul_f32 v[36:37], v[180:181], v[180:181]
  v_pk_mul_f32 v[38:39], v[182:183], v[182:183]
  v_pk_fma_f32 v[32:33], v[32:33], v[244:245], v[244:245] op_sel:[0,0,1] op_sel_hi:[1,0,1]
  v_pk_fma_f32 v[34:35], v[34:35], v[244:245], v[244:245] op_sel:[0,0,1] op_sel_hi:[1,0,1]
  v_pk_fma_f32 v[36:37], v[36:37], v[244:245], v[244:245] op_sel:[0,0,1] op_sel_hi:[1,0,1]
  v_pk_fma_f32 v[38:39], v[38:39], v[244:245], v[244:245] op_sel:[0,0,1] op_sel_hi:[1,0,1]
  v_pk_mul_f32 v[32:33], v[176:177], v[32:33]
  v_pk_mul_f32 v[34:35], v[178:179], v[34:35]
  v_pk_mul_f32 v[36:37], v[180:181], v[36:37]
  v_pk_mul_f32 v[38:39], v[182:183], v[38:39]
  v_exp_f32 v32, v32
  v_exp_f32 v33, v33
  v_exp_f32 v34, v34
  v_exp_f32 v35, v35
  v_exp_f32 v36, v36
  v_exp_f32 v37, v37
  v_exp_f32 v38, v38
  v_exp_f32 v39, v39
  v_pk_add_f32 v[32:33], v[32:33], 1.0 op_sel_hi:[1,0]
  v_pk_add_f32 v[34:35], v[34:35], 1.0 op_sel_hi:[1,0]
  v_pk_add_f32 v[36:37], v[36:37], 1.0 op_sel_hi:[1,0]
  v_pk_add_f32 v[38:39], v[38:39], 1.0 op_sel_hi:[1,0]
  v_rcp_f32 v32, v32
  v_rcp_f32 v33, v33
  v_rcp_f32 v34, v34
  v_rcp_f32 v35, v35
  v_rcp_f32 v36, v36
  v_rcp_f32 v37, v37
  v_rcp_f32 v38, v38
  v_rcp_f32 v39, v39
  v_pk_mul_f32 v[32:33], v[176:177], v[32:33]
  v_pk_mul_f32 v[34:35], v[178:179], v[34:35]
  v_pk_mul_f32 v[36:37], v[180:181], v[36:37]
  v_pk_mul_f32 v[38:39], v[182:183], v[38:39]
  v_cvt_pk_bf16_f32 v96, v32, v33
  v_cvt_pk_bf16_f32 v97, v34, v35
  v_cvt_pk_bf16_f32 v98, v36, v37
  v_cvt_pk_bf16_f32 v99, v38, v39
  s_add_u32 s63, s94, 4096
  buffer_store_dwordx4 v[96:99], v1, s[48:51], s63 offen offset:0 sc1
  ds_read_b128 v[64:67], v8 offset:1408
  ds_read_b128 v[68:71], v8 offset:1920
  ds_read_b128 v[72:75], v8 offset:1440
  ds_read_b128 v[76:79], v8 offset:1952
  s_waitcnt lgkmcnt(6)
  v_pk_fma_f32 v[84:85], v[242:243], v[80:81], v[84:85] op_sel_hi:[0,1,1] neg_lo:[1,0,0] neg_hi:[1,0,0]
  v_pk_fma_f32 v[86:87], v[242:243], v[82:83], v[86:87] op_sel_hi:[0,1,1] neg_lo:[1,0,0] neg_hi:[1,0,0]
  s_waitcnt lgkmcnt(4)
  v_pk_fma_f32 v[92:93], v[242:243], v[88:89], v[92:93] op_sel_hi:[0,1,1] neg_lo:[1,0,0] neg_hi:[1,0,0]
  v_pk_fma_f32 v[94:95], v[242:243], v[90:91], v[94:95] op_sel_hi:[0,1,1] neg_lo:[1,0,0] neg_hi:[1,0,0]
  v_pk_fma_f32 v[184:185], v[184:185], v[240:241], v[84:85] op_sel_hi:[1,0,1]
  v_pk_fma_f32 v[186:187], v[186:187], v[240:241], v[86:87] op_sel_hi:[1,0,1]
  v_pk_fma_f32 v[188:189], v[188:189], v[240:241], v[92:93] op_sel_hi:[1,0,1]
  v_pk_fma_f32 v[190:191], v[190:191], v[240:241], v[94:95] op_sel_hi:[1,0,1]
  v_pk_mul_f32 v[40:41], v[184:185], v[184:185]
  v_pk_mul_f32 v[42:43], v[186:187], v[186:187]
  v_pk_mul_f32 v[44:45], v[188:189], v[188:189]
  v_pk_mul_f32 v[46:47], v[190:191], v[190:191]
  v_pk_fma_f32 v[40:41], v[40:41], v[244:245], v[244:245] op_sel:[0,0,1] op_sel_hi:[1,0,1]
  v_pk_fma_f32 v[42:43], v[42:43], v[244:245], v[244:245] op_sel:[0,0,1] op_sel_hi:[1,0,1]
  v_pk_fma_f32 v[44:45], v[44:45], v[244:245], v[244:245] op_sel:[0,0,1] op_sel_hi:[1,0,1]
  v_pk_fma_f32 v[46:47], v[46:47], v[244:245], v[244:245] op_sel:[0,0,1] op_sel_hi:[1,0,1]
  v_pk_mul_f32 v[40:41], v[184:185], v[40:41]
  v_pk_mul_f32 v[42:43], v[186:187], v[42:43]
  v_pk_mul_f32 v[44:45], v[188:189], v[44:45]
  v_pk_mul_f32 v[46:47], v[190:191], v[46:47]
  v_exp_f32 v40, v40
  v_exp_f32 v41, v41
  v_exp_f32 v42, v42
  v_exp_f32 v43, v43
  v_exp_f32 v44, v44
  v_exp_f32 v45, v45
  v_exp_f32 v46, v46
  v_exp_f32 v47, v47
  v_pk_add_f32 v[40:41], v[40:41], 1.0 op_sel_hi:[1,0]
  v_pk_add_f32 v[42:43], v[42:43], 1.0 op_sel_hi:[1,0]
  v_pk_add_f32 v[44:45], v[44:45], 1.0 op_sel_hi:[1,0]
  v_pk_add_f32 v[46:47], v[46:47], 1.0 op_sel_hi:[1,0]
  v_rcp_f32 v40, v40
  v_rcp_f32 v41, v41
  v_rcp_f32 v42, v42
  v_rcp_f32 v43, v43
  v_rcp_f32 v44, v44
  v_rcp_f32 v45, v45
  v_rcp_f32 v46, v46
  v_rcp_f32 v47, v47
  v_pk_mul_f32 v[40:41], v[184:185], v[40:41]
  v_pk_mul_f32 v[42:43], v[186:187], v[42:43]
  v_pk_mul_f32 v[44:45], v[188:189], v[44:45]
  v_pk_mul_f32 v[46:47], v[190:191], v[46:47]
  v_cvt_pk_bf16_f32 v100, v40, v41
  v_cvt_pk_bf16_f32 v101, v42, v43
  v_cvt_pk_bf16_f32 v102, v44, v45
  v_cvt_pk_bf16_f32 v103, v46, v47
  s_add_u32 s63, s94, 4096
  buffer_store_dwordx4 v[100:103], v1, s[48:51], s63 offen offset:1024 sc1
  ds_read_b128 v[80:83], v8 offset:1472
  ds_read_b128 v[84:87], v8 offset:1984
  ds_read_b128 v[88:91], v8 offset:1504
  ds_read_b128 v[92:95], v8 offset:2016
  s_waitcnt lgkmcnt(6)
  v_pk_fma_f32 v[68:69], v[242:243], v[64:65], v[68:69] op_sel_hi:[0,1,1] neg_lo:[1,0,0] neg_hi:[1,0,0]
  v_pk_fma_f32 v[70:71], v[242:243], v[66:67], v[70:71] op_sel_hi:[0,1,1] neg_lo:[1,0,0] neg_hi:[1,0,0]
  s_waitcnt lgkmcnt(4)
  v_pk_fma_f32 v[76:77], v[242:243], v[72:73], v[76:77] op_sel_hi:[0,1,1] neg_lo:[1,0,0] neg_hi:[1,0,0]
  v_pk_fma_f32 v[78:79], v[242:243], v[74:75], v[78:79] op_sel_hi:[0,1,1] neg_lo:[1,0,0] neg_hi:[1,0,0]
  v_pk_fma_f32 v[192:193], v[192:193], v[240:241], v[68:69] op_sel_hi:[1,0,1]
  v_pk_fma_f32 v[194:195], v[194:195], v[240:241], v[70:71] op_sel_hi:[1,0,1]
  v_pk_fma_f32 v[196:197], v[196:197], v[240:241], v[76:77] op_sel_hi:[1,0,1]
  v_pk_fma_f32 v[198:199], v[198:199], v[240:241], v[78:79] op_sel_hi:[1,0,1]
  v_pk_mul_f32 v[32:33], v[192:193], v[192:193]
  v_pk_mul_f32 v[34:35], v[194:195], v[194:195]
  v_pk_mul_f32 v[36:37], v[196:197], v[196:197]
  v_pk_mul_f32 v[38:39], v[198:199], v[198:199]
  v_pk_fma_f32 v[32:33], v[32:33], v[244:245], v[244:245] op_sel:[0,0,1] op_sel_hi:[1,0,1]
  v_pk_fma_f32 v[34:35], v[34:35], v[244:245], v[244:245] op_sel:[0,0,1] op_sel_hi:[1,0,1]
  v_pk_fma_f32 v[36:37], v[36:37], v[244:245], v[244:245] op_sel:[0,0,1] op_sel_hi:[1,0,1]
  v_pk_fma_f32 v[38:39], v[38:39], v[244:245], v[244:245] op_sel:[0,0,1] op_sel_hi:[1,0,1]
  v_pk_mul_f32 v[32:33], v[192:193], v[32:33]
  v_pk_mul_f32 v[34:35], v[194:195], v[34:35]
  v_pk_mul_f32 v[36:37], v[196:197], v[36:37]
  v_pk_mul_f32 v[38:39], v[198:199], v[38:39]
  v_exp_f32 v32, v32
  v_exp_f32 v33, v33
  v_exp_f32 v34, v34
  v_exp_f32 v35, v35
  v_exp_f32 v36, v36
  v_exp_f32 v37, v37
  v_exp_f32 v38, v38
  v_exp_f32 v39, v39
  v_pk_add_f32 v[32:33], v[32:33], 1.0 op_sel_hi:[1,0]
  v_pk_add_f32 v[34:35], v[34:35], 1.0 op_sel_hi:[1,0]
  v_pk_add_f32 v[36:37], v[36:37], 1.0 op_sel_hi:[1,0]
  v_pk_add_f32 v[38:39], v[38:39], 1.0 op_sel_hi:[1,0]
  v_rcp_f32 v32, v32
  v_rcp_f32 v33, v33
  v_rcp_f32 v34, v34
  v_rcp_f32 v35, v35
  v_rcp_f32 v36, v36
  v_rcp_f32 v37, v37
  v_rcp_f32 v38, v38
  v_rcp_f32 v39, v39
  v_pk_mul_f32 v[32:33], v[192:193], v[32:33]
  v_pk_mul_f32 v[34:35], v[194:195], v[34:35]
  v_pk_mul_f32 v[36:37], v[196:197], v[36:37]
  v_pk_mul_f32 v[38:39], v[198:199], v[38:39]
  v_cvt_pk_bf16_f32 v96, v32, v33
  v_cvt_pk_bf16_f32 v97, v34, v35
  v_cvt_pk_bf16_f32 v98, v36, v37
  v_cvt_pk_bf16_f32 v99, v38, v39
  s_add_u32 s63, s94, 4096
  buffer_store_dwordx4 v[96:99], v1, s[48:51], s63 offen offset:2048 sc1
  s_add_u32 s92, s57, 48
  s_waitcnt vmcnt(3)
  s_mov_b64 s[64:65], exec
  s_mov_b64 exec, 1
  v_mov_b32 v9, 161800
  v_mov_b32 v10, 1
  ds_add_rtn_u32 v9, v9, v10
  s_waitcnt lgkmcnt(0)
  v_readfirstlane_b32 s62, v9
  s_cmp_lg_u32 s62, 3
  s_cbranch_scc1 sig_38_87c0
  s_cmp_eq_u32 s89, 0
  s_cbranch_scc1 sigg_39_87c0
  s_lshl_b32 s62, s92, 7
  s_lshl_b32 s63, s58, 2
  s_add_u32 s62, s62, s63
  s_add_u32 s62, s62, 12091392
  v_mov_b32 v9, s62
  global_store_dword v9, v10, s[24:25]
  s_branch sig_38_87c0
sigg_39_87c0:
  s_lshl_b32 s62, s92, 8
  s_add_u32 s62, s62, 12058624
  v_mov_b32 v9, s62
  global_atomic_add v9, v10, s[24:25]
sig_38_87c0:
  s_mov_b64 exec, s[64:65]
  v_pk_fma_f32 v[84:85], v[242:243], v[80:81], v[84:85] op_sel_hi:[0,1,1] neg_lo:[1,0,0] neg_hi:[1,0,0]
  v_pk_fma_f32 v[86:87], v[242:243], v[82:83], v[86:87] op_sel_hi:[0,1,1] neg_lo:[1,0,0] neg_hi:[1,0,0]
  v_pk_fma_f32 v[92:93], v[242:243], v[88:89], v[92:93] op_sel_hi:[0,1,1] neg_lo:[1,0,0] neg_hi:[1,0,0]
  v_pk_fma_f32 v[94:95], v[242:243], v[90:91], v[94:95] op_sel_hi:[0,1,1] neg_lo:[1,0,0] neg_hi:[1,0,0]
  v_pk_fma_f32 v[200:201], v[200:201], v[240:241], v[84:85] op_sel_hi:[1,0,1]
  v_pk_fma_f32 v[202:203], v[202:203], v[240:241], v[86:87] op_sel_hi:[1,0,1]
  v_pk_fma_f32 v[204:205], v[204:205], v[240:241], v[92:93] op_sel_hi:[1,0,1]
  v_pk_fma_f32 v[206:207], v[206:207], v[240:241], v[94:95] op_sel_hi:[1,0,1]
  v_pk_mul_f32 v[40:41], v[200:201], v[200:201]
  v_pk_mul_f32 v[42:43], v[202:203], v[202:203]
  v_pk_mul_f32 v[44:45], v[204:205], v[204:205]
  v_pk_mul_f32 v[46:47], v[206:207], v[206:207]
  v_pk_fma_f32 v[40:41], v[40:41], v[244:245], v[244:245] op_sel:[0,0,1] op_sel_hi:[1,0,1]
  v_pk_fma_f32 v[42:43], v[42:43], v[244:245], v[244:245] op_sel:[0,0,1] op_sel_hi:[1,0,1]
  v_pk_fma_f32 v[44:45], v[44:45], v[244:245], v[244:245] op_sel:[0,0,1] op_sel_hi:[1,0,1]
  v_pk_fma_f32 v[46:47], v[46:47], v[244:245], v[244:245] op_sel:[0,0,1] op_sel_hi:[1,0,1]
  v_pk_mul_f32 v[40:41], v[200:201], v[40:41]
  v_pk_mul_f32 v[42:43], v[202:203], v[42:43]
  v_pk_mul_f32 v[44:45], v[204:205], v[44:45]
  v_pk_mul_f32 v[46:47], v[206:207], v[46:47]
  v_exp_f32 v40, v40
  v_exp_f32 v41, v41
  v_exp_f32 v42, v42
  v_exp_f32 v43, v43
  v_exp_f32 v44, v44
  v_exp_f32 v45, v45
  v_exp_f32 v46, v46
  v_exp_f32 v47, v47
  v_pk_add_f32 v[40:41], v[40:41], 1.0 op_sel_hi:[1,0]
  v_pk_add_f32 v[42:43], v[42:43], 1.0 op_sel_hi:[1,0]
  v_pk_add_f32 v[44:45], v[44:45], 1.0 op_sel_hi:[1,0]
  v_pk_add_f32 v[46:47], v[46:47], 1.0 op_sel_hi:[1,0]
  v_rcp_f32 v40, v40
  v_rcp_f32 v41, v41
  v_rcp_f32 v42, v42
  v_rcp_f32 v43, v43
  v_rcp_f32 v44, v44
  v_rcp_f32 v45, v45
  v_rcp_f32 v46, v46
  v_rcp_f32 v47, v47
  v_pk_mul_f32 v[40:41], v[200:201], v[40:41]
  v_pk_mul_f32 v[42:43], v[202:203], v[42:43]
  v_pk_mul_f32 v[44:45], v[204:205], v[44:45]
  v_pk_mul_f32 v[46:47], v[206:207], v[46:47]
  v_cvt_pk_bf16_f32 v100, v40, v41
  v_cvt_pk_bf16_f32 v101, v42, v43
  v_cvt_pk_bf16_f32 v102, v44, v45
  v_cvt_pk_bf16_f32 v103, v46, v47
  s_add_u32 s63, s94, 4096
  buffer_store_dwordx4 v[100:103], v1, s[48:51], s63 offen offset:3072 sc1
  s_branch p3done_26_87c0
p3skip_25_87c0:
  s_add_u32 s92, s57, 32
  s_waitcnt vmcnt(0)
  s_mov_b64 s[64:65], exec
  s_mov_b64 exec, 1
  v_mov_b32 v2, 161796
  v_mov_b32 v3, 1
  ds_add_rtn_u32 v2, v2, v3
  s_waitcnt lgkmcnt(0)
  v_readfirstlane_b32 s62, v2
  s_cmp_lg_u32 s62, 3
  s_cbranch_scc1 sig_40_87c0
  s_cmp_eq_u32 s89, 0
  s_cbranch_scc1 sigg_41_87c0
  s_lshl_b32 s62, s92, 7
  s_lshl_b32 s63, s58, 2
  s_add_u32 s62, s62, s63
  s_add_u32 s62, s62, 12091392
  v_mov_b32 v2, s62
  global_store_dword v2, v3, s[24:25]
  s_branch sig_40_87c0
sigg_41_87c0:
  s_lshl_b32 s62, s92, 8
  s_add_u32 s62, s62, 12058624
  v_mov_b32 v2, s62
  global_atomic_add v2, v3, s[24:25]
sig_40_87c0:
  s_mov_b64 exec, s[64:65]
  s_and_b32 s62, s57, 1
  s_lshl_b32 s62, s62, 1
  s_add_u32 s62, s62, s58
  s_sub_u32 s62, s62, 14
  s_lshl_b32 s62, s62, 2
  s_add_u32 s62, s62, s56
  s_mul_i32 s62, s62, 448
  v_add_u32 v16, s62, v0
  v_add_u32 v17, 0, v16
  v_lshrrev_b32 v18, 9, v17
  v_bfe_u32 v19, v17, 3, 6
  v_lshl_add_u32 v18, v18, 7, v19
  v_and_b32 v19, 7, v17
  v_lshlrev_b32 v18, 10, v18
  v_lshl_add_u32 v18, v19, 7, v18
  global_load_dword v20, v18, s[16:17] offset:0
  v_add_u32 v17, 64, v16
  v_lshrrev_b32 v18, 9, v17
  v_bfe_u32 v19, v17, 3, 6
  v_lshl_add_u32 v18, v18, 7, v19
  v_and_b32 v19, 7, v17
  v_lshlrev_b32 v18, 10, v18
  v_lshl_add_u32 v18, v19, 7, v18
  global_load_dword v21, v18, s[16:17] offset:0
  v_add_u32 v17, 128, v16
  v_lshrrev_b32 v18, 9, v17
  v_bfe_u32 v19, v17, 3, 6
  v_lshl_add_u32 v18, v18, 7, v19
  v_and_b32 v19, 7, v17
  v_lshlrev_b32 v18, 10, v18
  v_lshl_add_u32 v18, v19, 7, v18
  global_load_dword v22, v18, s[16:17] offset:0
  v_add_u32 v17, 192, v16
  v_lshrrev_b32 v18, 9, v17
  v_bfe_u32 v19, v17, 3, 6
  v_lshl_add_u32 v18, v18, 7, v19
  v_and_b32 v19, 7, v17
  v_lshlrev_b32 v18, 10, v18
  v_lshl_add_u32 v18, v19, 7, v18
  global_load_dword v23, v18, s[16:17] offset:0
  v_add_u32 v17, 256, v16
  v_lshrrev_b32 v18, 9, v17
  v_bfe_u32 v19, v17, 3, 6
  v_lshl_add_u32 v18, v18, 7, v19
  v_and_b32 v19, 7, v17
  v_lshlrev_b32 v18, 10, v18
  v_lshl_add_u32 v18, v19, 7, v18
  s_waitcnt vmcnt(3)
  global_load_dword v20, v18, s[16:17] offset:0
  v_add_u32 v17, 320, v16
  v_lshrrev_b32 v18, 9, v17
  v_bfe_u32 v19, v17, 3, 6
  v_lshl_add_u32 v18, v18, 7, v19
  v_and_b32 v19, 7, v17
  v_lshlrev_b32 v18, 10, v18
  v_lshl_add_u32 v18, v19, 7, v18
  s_waitcnt vmcnt(3)
  global_load_dword v21, v18, s[16:17] offset:0
  v_add_u32 v17, 384, v16
  v_lshrrev_b32 v18, 9, v17
  v_bfe_u32 v19, v17, 3, 6
  v_lshl_add_u32 v18, v18, 7, v19
  v_and_b32 v19, 7, v17
  v_lshlrev_b32 v18, 10, v18
  v_lshl_add_u32 v18, v19, 7, v18
  s_waitcnt vmcnt(3)
  global_load_dword v22, v18, s[16:17] offset:0
  v_add_u32 v17, 0, v16
  v_lshrrev_b32 v18, 9, v17
  v_bfe_u32 v19, v17, 3, 6
  v_lshl_add_u32 v18, v18, 7, v19
  v_add_u32 v18, 64, v18
  v_and_b32 v19, 7, v17
  v_lshlrev_b32 v18, 10, v18
  v_lshl_add_u32 v18, v19, 7, v18
  global_load_dword v24, v18, s[16:17]
  v_add_u32 v17, 64, v16
  v_lshrrev_b32 v18, 9, v17
  v_bfe_u32 v19, v17, 3, 6
  v_lshl_add_u32 v18, v18, 7, v19
  v_add_u32 v18, 64, v18
  v_and_b32 v19, 7, v17
  v_lshlrev_b32 v18, 10, v18
  v_lshl_add_u32 v18, v19, 7, v18
  global_load_dword v25, v18, s[16:17]
  v_add_u32 v17, 128, v16
  v_lshrrev_b32 v18, 9, v17
  v_bfe_u32 v19, v17, 3, 6
  v_lshl_add_u32 v18, v18, 7, v19
  v_add_u32 v18, 64, v18
  v_and_b32 v19, 7, v17
  v_lshlrev_b32 v18, 10, v18
  v_lshl_add_u32 v18, v19, 7, v18
  global_load_dword v26, v18, s[16:17]
  v_add_u32 v17, 192, v16
  v_lshrrev_b32 v18, 9, v17
  v_bfe_u32 v19, v17, 3, 6
  v_lshl_add_u32 v18, v18, 7, v19
  v_add_u32 v18, 64, v18
  v_and_b32 v19, 7, v17
  v_lshlrev_b32 v18, 10, v18
  v_lshl_add_u32 v18, v19, 7, v18
  global_load_dword v27, v18, s[16:17]
  v_add_u32 v17, 256, v16
  v_lshrrev_b32 v18, 9, v17
  v_bfe_u32 v19, v17, 3, 6
  v_lshl_add_u32 v18, v18, 7, v19
  v_add_u32 v18, 64, v18
  v_and_b32 v19, 7, v17
  v_lshlrev_b32 v18, 10, v18
  v_lshl_add_u32 v18, v19, 7, v18
  s_waitcnt vmcnt(3)
  global_load_dword v24, v18, s[16:17]
  v_add_u32 v17, 320, v16
  v_lshrrev_b32 v18, 9, v17
  v_bfe_u32 v19, v17, 3, 6
  v_lshl_add_u32 v18, v18, 7, v19
  v_add_u32 v18, 64, v18
  v_and_b32 v19, 7, v17
  v_lshlrev_b32 v18, 10, v18
  v_lshl_add_u32 v18, v19, 7, v18
  s_waitcnt vmcnt(3)
  global_load_dword v25, v18, s[16:17]
  v_add_u32 v17, 384, v16
  v_lshrrev_b32 v18, 9, v17
  v_bfe_u32 v19, v17, 3, 6
  v_lshl_add_u32 v18, v18, 7, v19
  v_add_u32 v18, 64, v18
  v_and_b32 v19, 7, v17
  v_lshlrev_b32 v18, 10, v18
  v_lshl_add_u32 v18, v19, 7, v18
  s_waitcnt vmcnt(3)
  global_load_dword v26, v18, s[16:17]
  s_barrier
  s_barrier
  s_barrier
  s_waitcnt vmcnt(0) lgkmcnt(0)
p3done_26_87c0:
  s_lshr_b32 s90, s56, 1
  s_and_b32 s91, s56, 1
  s_mul_i32 s62, s91, 14336
  v_lshrrev_b32 v2, 5, v0
  v_bfe_u32 v3, v0, 2, 2
  v_lshl_add_u32 v2, v2, 2, v3
  v_lshlrev_b32 v2, 7, v2
  v_lshrrev_b32 v3, 1, v3
  v_lshl_add_u32 v2, v3, 6, v2
  v_bfe_u32 v3, v0, 4, 1
  v_lshl_add_u32 v2, v3, 5, v2
  v_and_b32 v3, 3, v0
  v_lshl_add_u32 v2, v3, 3, v2
  v_add_u32 v2, s62, v2
  v_add_u32 v2, 131072, v2
  v_mov_b32 v4, v2
  v_xor_b32 v5, 64, v2
  s_lshl_b32 s62, s91, 6
  v_xor_b32 v4, s62, v4
  v_xor_b32 v5, 64, v4
  s_barrier
  ds_read_b64_tr_b16 v[16:17], v4 offset:0
  ds_read_b64_tr_b16 v[18:19], v4 offset:1024
  ds_read_b64_tr_b16 v[20:21], v5 offset:0
  ds_read_b64_tr_b16 v[22:23], v5 offset:1024
  ds_read_b64_tr_b16 v[24:25], v4 offset:2048
  ds_read_b64_tr_b16 v[26:27], v4 offset:3072
  ds_read_b64_tr_b16 v[28:29], v5 offset:2048
  ds_read_b64_tr_b16 v[30:31], v5 offset:3072
  ds_read_b64_tr_b16 v[32:33], v4 offset:4096
  ds_read_b64_tr_b16 v[34:35], v4 offset:5120
  ds_read_b64_tr_b16 v[36:37], v5 offset:4096
  ds_read_b64_tr_b16 v[38:39], v5 offset:5120
  ds_read_b64_tr_b16 v[40:41], v4 offset:6144
  ds_read_b64_tr_b16 v[42:43], v4 offset:7168
  ds_read_b64_tr_b16 v[44:45], v5 offset:6144
  s_waitcnt lgkmcnt(14)
  ds_read_b64_tr_b16 v[46:47], v5 offset:7168
  s_waitcnt lgkmcnt(14)
  ds_read_b64_tr_b16 v[48:49], v4 offset:8192
  s_waitcnt lgkmcnt(14)
  ds_read_b64_tr_b16 v[50:51], v4 offset:9216
  s_waitcnt lgkmcnt(14)
  ds_read_b64_tr_b16 v[52:53], v5 offset:8192
  s_waitcnt lgkmcnt(14)
  ds_read_b64_tr_b16 v[54:55], v5 offset:9216
  s_waitcnt lgkmcnt(14)
  ds_read_b64_tr_b16 v[56:57], v4 offset:10240
  s_waitcnt lgkmcnt(14)
  ds_read_b64_tr_b16 v[58:59], v4 offset:11264
  s_waitcnt lgkmcnt(14)
  ds_read_b64_tr_b16 v[60:61], v5 offset:10240
  s_waitcnt lgkmcnt(14)
  ds_read_b64_tr_b16 v[62:63], v5 offset:11264
  s_waitcnt lgkmcnt(14)
  ds_read_b64_tr_b16 v[64:65], v4 offset:12288
  s_waitcnt lgkmcnt(14)
  ds_read_b64_tr_b16 v[66:67], v4 offset:13312
  s_waitcnt lgkmcnt(14)
  ds_read_b64_tr_b16 v[68:69], v5 offset:12288
  s_waitcnt lgkmcnt(14)
  ds_read_b64_tr_b16 v[70:71], v5 offset:13312
  v_add_u32 v4, 4294901760, v4
  v_add_u32 v5, 4294901760, v5
  s_waitcnt lgkmcnt(14)
  ds_read_b64_tr_b16 v[72:73], v4 offset:0
  s_waitcnt lgkmcnt(14)
  ds_read_b64_tr_b16 v[74:75], v4 offset:1024
  s_waitcnt lgkmcnt(14)
  ds_read_b64_tr_b16 v[76:77], v5 offset:0
  s_waitcnt lgkmcnt(14)
  ds_read_b64_tr_b16 v[78:79], v5 offset:1024
  s_waitcnt lgkmcnt(14)
  ds_read_b64_tr_b16 v[80:81], v4 offset:2048
  s_waitcnt lgkmcnt(14)
  ds_read_b64_tr_b16 v[82:83], v4 offset:3072
  s_waitcnt lgkmcnt(14)
  ds_read_b64_tr_b16 v[84:85], v5 offset:2048
  s_waitcnt lgkmcnt(14)
  ds_read_b64_tr_b16 v[86:87], v5 offset:3072
  s_waitcnt lgkmcnt(14)
  ds_read_b64_tr_b16 v[88:89], v4 offset:4096
  s_waitcnt lgkmcnt(14)
  ds_read_b64_tr_b16 v[90:91], v4 offset:5120
  s_waitcnt lgkmcnt(14)
  ds_read_b64_tr_b16 v[92:93], v5 offset:4096
  s_waitcnt lgkmcnt(14)
  ds_read_b64_tr_b16 v[94:95], v5 offset:5120
  s_waitcnt lgkmcnt(14)
  ds_read_b64_tr_b16 v[96:97], v4 offset:6144
  s_waitcnt lgkmcnt(14)
  ds_read_b64_tr_b16 v[98:99], v4 offset:7168
  s_waitcnt lgkmcnt(14)
  ds_read_b64_tr_b16 v[100:101], v5 offset:6144
  s_waitcnt lgkmcnt(14)
  ds_read_b64_tr_b16 v[102:103], v5 offset:7168
  s_waitcnt lgkmcnt(14)
  ds_read_b64_tr_b16 v[104:105], v4 offset:8192
  s_waitcnt lgkmcnt(14)
  ds_read_b64_tr_b16 v[106:107], v4 offset:9216
  s_waitcnt lgkmcnt(14)
  ds_read_b64_tr_b16 v[108:109], v5 offset:8192
  s_waitcnt lgkmcnt(14)
  ds_read_b64_tr_b16 v[110:111], v5 offset:9216
  s_waitcnt lgkmcnt(14)
  ds_read_b64_tr_b16 v[112:113], v4 offset:10240
  s_waitcnt lgkmcnt(14)
  ds_read_b64_tr_b16 v[114:115], v4 offset:11264
  s_waitcnt lgkmcnt(14)
  ds_read_b64_tr_b16 v[116:117], v5 offset:10240
  s_waitcnt lgkmcnt(14)
  ds_read_b64_tr_b16 v[118:119], v5 offset:11264
  s_waitcnt lgkmcnt(14)
  ds_read_b64_tr_b16 v[120:121], v4 offset:12288
  s_waitcnt lgkmcnt(14)
  ds_read_b64_tr_b16 v[122:123], v4 offset:13312
  s_waitcnt lgkmcnt(14)
  ds_read_b64_tr_b16 v[124:125], v5 offset:12288
  s_waitcnt lgkmcnt(14)
  ds_read_b64_tr_b16 v[126:127], v5 offset:13312
  v_add_u32 v4, 4294901760, v4
  v_add_u32 v5, 4294901760, v5
  s_lshl_b32 s62, s60, 7
  s_lshl_b32 s63, s91, 6
  s_add_u32 s62, s62, s63
  v_lshrrev_b32 v2, 5, v0
  v_lshlrev_b32 v2, 3, v2
  v_add_u32 v2, s62, v2
  s_waitcnt lgkmcnt(0)
  s_cmp_ge_u32 s58, 14
  s_cbranch_scc1 nsig3_42_87c0
  s_add_u32 s92, s57, 64
  s_waitcnt vmcnt(0)
  s_mov_b64 s[64:65], exec
  s_mov_b64 exec, 1
  v_mov_b32 v9, 161804
  v_mov_b32 v10, 1
  ds_add_rtn_u32 v9, v9, v10
  s_waitcnt lgkmcnt(0)
  v_readfirstlane_b32 s62, v9
  s_cmp_lg_u32 s62, 3
  s_cbranch_scc1 sig_43_87c0
  s_cmp_eq_u32 s89, 0
  s_cbranch_scc1 sigg_44_87c0
  s_lshl_b32 s62, s92, 7
  s_lshl_b32 s63, s58, 2
  s_add_u32 s62, s62, s63
  s_add_u32 s62, s62, 12091392
  v_mov_b32 v9, s62
  global_store_dword v9, v10, s[24:25]
  s_branch sig_43_87c0
sigg_44_87c0:
  s_lshl_b32 s62, s92, 8
  s_add_u32 s62, s62, 12058624
  v_mov_b32 v9, s62
  global_atomic_add v9, v10, s[24:25]
sig_43_87c0:
  s_mov_b64 exec, s[64:65]
nsig3_42_87c0:
  s_barrier
  global_load_dwordx2 v[240:241], v2, s[18:19] offset:0
  global_load_dwordx2 v[242:243], v2, s[18:19] offset:16
  global_load_dwordx2 v[244:245], v2, s[18:19] offset:32
  global_load_dwordx2 v[246:247], v2, s[18:19] offset:48
  s_lshl_b32 s62, s59, 1
  s_add_u32 s62, s62, s90
  s_mul_i32 s92, s62, 114688
  s_mul_i32 s62, s91, 57344
  s_add_u32 s92, s92, s62
  s_add_u32 s92, s92, 4194304
  s_add_u32 s94, s57, 48
  s_mov_b32 s68, 0
  s_mov_b32 s69, 8192
  s_mov_b32 s70, 16384
  s_mov_b32 s71, 24576
  s_mov_b32 s72, 32768
  s_mov_b32 s73, 40960
  s_mov_b32 s74, 49152
  s_add_u32 s68, s68, s92
  s_add_u32 s69, s69, s92
  s_add_u32 s70, s70, s92
  s_add_u32 s71, s71, s92
  s_add_u32 s72, s72, s92
  s_add_u32 s73, s73, s92
  s_add_u32 s74, s74, s92
  s_cmp_lg_u32 s89, 0
  s_cbranch_scc1 me_47_87c0
  s_cmp_lg_u32 s56, 0
  s_cbranch_scc1 wo_45_87c0
me_47_87c0:
  s_cmp_eq_u32 s89, 0
  s_cbranch_scc1 pg_48_87c0
  s_lshl_b32 s62, s94, 7
  s_add_u32 s62, s62, 12091392
  v_and_b32 v9, 15, v0
  v_lshl_add_u32 v9, v9, 2, s62
  s_mov_b32 s66, 262144
  s_mov_b64 exec, 0x3fff
pl_50_87c0:
  global_load_dword v10, v9, s[24:25] sc1
  s_sub_u32 s66, s66, 1
  s_waitcnt vmcnt(0)
  v_cmp_ne_u32 vcc, 1, v10
  s_cmp_eq_u32 s66, 0
  s_cbranch_scc1 pl_50_87c0x
  s_nop 3
  s_cbranch_vccnz pl_50_87c0
pl_50_87c0x:
  s_mov_b64 exec, -1
  s_branch pe_49_87c0
pg_48_87c0:
  s_lshl_b32 s62, s94, 8
  s_add_u32 s62, s62, 12058624
  v_mov_b32 v9, s62
  s_mov_b32 s66, 262144
poll_51_87c0:
  global_load_dword v10, v9, s[24:25] sc1
  s_sub_u32 s66, s66, 1
  s_waitcnt vmcnt(0)
  v_readfirstlane_b32 s62, v10
  s_cmp_eq_u32 s66, 0
  s_cbranch_scc1 pdone_52_87c0
  s_cmp_ge_u32 s62, 14
  s_cbranch_scc1 pdone_52_87c0
  s_sleep 1
  s_branch poll_51_87c0
pdone_52_87c0:
pe_49_87c0:
  v_mov_b32 v9, 161816
  v_mov_b32 v10, 1
  ds_write_b32 v9, v10
  s_waitcnt lgkmcnt(0)
  s_branch wd_46_87c0
wo_45_87c0:
  v_mov_b32 v9, 161816
  s_mov_b32 s66, 2097152
lp_53_87c0:
  ds_read_b32 v10, v9
  s_sub_u32 s66, s66, 1
  s_waitcnt lgkmcnt(0)
  v_readfirstlane_b32 s62, v10
  s_cmp_eq_u32 s66, 0
  s_cbranch_scc1 wd_46_87c0
  s_cmp_eq_u32 s62, 0
  s_cbranch_scc1 lp_53_87c0
wd_46_87c0:
  s_add_u32 s93, s68, 0
  buffer_load_dwordx4 v[160:163], v1, s[48:51], s93 offen offset:0 sc1
  buffer_load_dwordx4 v[164:167], v1, s[48:51], s93 offen offset:1024 sc1
  buffer_load_dwordx4 v[168:171], v1, s[48:51], s93 offen offset:2048 sc1
  buffer_load_dwordx4 v[172:175], v1, s[48:51], s93 offen offset:3072 sc1
  s_add_u32 s93, s69, 0
  buffer_load_dwordx4 v[176:179], v1, s[48:51], s93 offen offset:0 sc1
  buffer_load_dwordx4 v[180:183], v1, s[48:51], s93 offen offset:1024 sc1
  buffer_load_dwordx4 v[184:187], v1, s[48:51], s93 offen offset:2048 sc1
  buffer_load_dwordx4 v[188:191], v1, s[48:51], s93 offen offset:3072 sc1
  s_add_u32 s93, s70, 0
  buffer_load_dwordx4 v[192:195], v1, s[48:51], s93 offen offset:0 sc1
  buffer_load_dwordx4 v[196:199], v1, s[48:51], s93 offen offset:1024 sc1
  buffer_load_dwordx4 v[200:203], v1, s[48:51], s93 offen offset:2048 sc1
  s_waitcnt vmcnt(10)
  v_mfma_f32_32x32x16_bf16 v[208:223], v[16:19], v[160:163], 0
  v_mfma_f32_32x32x16_bf16 v[224:239], v[20:23], v[160:163], 0
  buffer_load_dwordx4 v[204:207], v1, s[48:51], s93 offen offset:3072 sc1
  s_waitcnt vmcnt(10)
  v_mfma_f32_32x32x16_bf16 v[208:223], v[24:27], v[164:167], v[208:223]
  s_add_u32 s93, s71, 0
  v_mfma_f32_32x32x16_bf16 v[224:239], v[28:31], v[164:167], v[224:239]
  buffer_load_dwordx4 v[160:163], v1, s[48:51], s93 offen offset:0 sc1
  s_waitcnt vmcnt(10)
  v_mfma_f32_32x32x16_bf16 v[208:223], v[32:35], v[168:171], v[208:223]
  v_mfma_f32_32x32x16_bf16 v[224:239], v[36:39], v[168:171], v[224:239]
  buffer_load_dwordx4 v[164:167], v1, s[48:51], s93 offen offset:1024 sc1
  s_waitcnt vmcnt(10)
  v_mfma_f32_32x32x16_bf16 v[208:223], v[40:43], v[172:175], v[208:223]
  v_mfma_f32_32x32x16_bf16 v[224:239], v[44:47], v[172:175], v[224:239]
  buffer_load_dwordx4 v[168:171], v1, s[48:51], s93 offen offset:2048 sc1
  s_waitcnt vmcnt(10)
  v_mfma_f32_32x32x16_bf16 v[208:223], v[48:51], v[176:179], v[208:223]
  v_mfma_f32_32x32x16_bf16 v[224:239], v[52:55], v[176:179], v[224:239]
  buffer_load_dwordx4 v[172:175], v1, s[48:51], s93 offen offset:3072 sc1
  s_waitcnt vmcnt(10)
  v_mfma_f32_32x32x16_bf16 v[208:223], v[56:59], v[180:183], v[208:223]
  s_add_u32 s93, s72, 0
  v_mfma_f32_32x32x16_bf16 v[224:239], v[60:63], v[180:183], v[224:239]
  buffer_load_dwordx4 v[176:179], v1, s[48:51], s93 offen offset:0 sc1
  s_waitcnt vmcnt(10)
  v_mfma_f32_32x32x16_bf16 v[208:223], v[64:67], v[184:187], v[208:223]
  v_mfma_f32_32x32x16_bf16 v[224:239], v[68:71], v[184:187], v[224:239]
  buffer_load_dwordx4 v[180:183], v1, s[48:51], s93 offen offset:1024 sc1
  s_waitcnt vmcnt(10)
  v_mfma_f32_32x32x16_bf16 v[208:223], v[72:75], v[188:191], v[208:223]
  v_mfma_f32_32x32x16_bf16 v[224:239], v[76:79], v[188:191], v[224:239]
  buffer_load_dwordx4 v[184:187], v1, s[48:51], s93 offen offset:2048 sc1
  s_waitcnt vmcnt(10)
  v_mfma_f32_32x32x16_bf16 v[208:223], v[80:83], v[192:195], v[208:223]
  v_mfma_f32_32x32x16_bf16 v[224:239], v[84:87], v[192:195], v[224:239]
  buffer_load_dwordx4 v[188:191], v1, s[48:51], s93 offen offset:3072 sc1
  s_waitcnt vmcnt(10)
  v_mfma_f32_32x32x16_bf16 v[208:223], v[88:91], v[196:199], v[208:223]
  s_add_u32 s93, s73, 0
  v_mfma_f32_32x32x16_bf16 v[224:239], v[92:95], v[196:199], v[224:239]
  buffer_load_dwordx4 v[192:195], v1, s[48:51], s93 offen offset:0 sc1
  s_waitcnt vmcnt(10)
  v_mfma_f32_32x32x16_bf16 v[208:223], v[96:99], v[200:203], v[208:223]
  v_mfma_f32_32x32x16_bf16 v[224:239], v[100:103], v[200:203], v[224:239]
  buffer_load_dwordx4 v[196:199], v1, s[48:51], s93 offen offset:1024 sc1
  s_waitcnt vmcnt(10)
  v_mfma_f32_32x32x16_bf16 v[208:223], v[104:107], v[204:207], v[208:223]
  v_mfma_f32_32x32x16_bf16 v[224:239], v[108:111], v[204:207], v[224:239]
  buffer_load_dwordx4 v[200:203], v1, s[48:51], s93 offen offset:2048 sc1
  s_waitcnt vmcnt(10)
  v_mfma_f32_32x32x16_bf16 v[208:223], v[112:115], v[160:163], v[208:223]
  v_mfma_f32_32x32x16_bf16 v[224:239], v[116:119], v[160:163], v[224:239]
  buffer_load_dwordx4 v[204:207], v1, s[48:51], s93 offen offset:3072 sc1
  s_waitcnt vmcnt(10)
  v_mfma_f32_32x32x16_bf16 v[208:223], v[120:123], v[164:167], v[208:223]
  s_add_u32 s93, s74, 0
  v_mfma_f32_32x32x16_bf16 v[224:239], v[124:127], v[164:167], v[224:239]
  buffer_load_dwordx4 v[160:163], v1, s[48:51], s93 offen offset:0 sc1
  ds_read_b64_tr_b16 v[144:145], v4 offset:0
  ds_read_b64_tr_b16 v[146:147], v4 offset:1024
  ds_read_b64_tr_b16 v[148:149], v5 offset:0
  ds_read_b64_tr_b16 v[150:151], v5 offset:1024
  ds_read_b64_tr_b16 v[152:153], v4 offset:2048
  ds_read_b64_tr_b16 v[154:155], v4 offset:3072
  ds_read_b64_tr_b16 v[156:157], v5 offset:2048
  ds_read_b64_tr_b16 v[158:159], v5 offset:3072
  s_waitcnt vmcnt(10) lgkmcnt(6)
  v_mfma_f32_32x32x16_bf16 v[208:223], v[144:147], v[168:171], v[208:223]
  buffer_load_dwordx4 v[164:167], v1, s[48:51], s93 offen offset:1024 sc1
  ds_read_b64_tr_b16 v[128:129], v4 offset:4096
  s_waitcnt lgkmcnt(5)
  v_mfma_f32_32x32x16_bf16 v[224:239], v[148:151], v[168:171], v[224:239]
  ds_read_b64_tr_b16 v[130:131], v4 offset:5120
  ds_read_b64_tr_b16 v[132:133], v5 offset:4096
  ds_read_b64_tr_b16 v[134:135], v5 offset:5120
  s_waitcnt vmcnt(10) lgkmcnt(6)
  v_mfma_f32_32x32x16_bf16 v[208:223], v[152:155], v[172:175], v[208:223]
  buffer_load_dwordx4 v[168:171], v1, s[48:51], s93 offen offset:2048 sc1
  ds_read_b64_tr_b16 v[136:137], v4 offset:6144
  s_waitcnt lgkmcnt(5)
  v_mfma_f32_32x32x16_bf16 v[224:239], v[156:159], v[172:175], v[224:239]
  ds_read_b64_tr_b16 v[138:139], v4 offset:7168
  ds_read_b64_tr_b16 v[140:141], v5 offset:6144
  ds_read_b64_tr_b16 v[142:143], v5 offset:7168
  s_waitcnt vmcnt(10) lgkmcnt(6)
  v_mfma_f32_32x32x16_bf16 v[208:223], v[128:131], v[176:179], v[208:223]
  buffer_load_dwordx4 v[172:175], v1, s[48:51], s93 offen offset:3072 sc1
  ds_read_b64_tr_b16 v[144:145], v4 offset:8192
  s_waitcnt lgkmcnt(5)
  v_mfma_f32_32x32x16_bf16 v[224:239], v[132:135], v[176:179], v[224:239]
  ds_read_b64_tr_b16 v[146:147], v4 offset:9216
  ds_read_b64_tr_b16 v[148:149], v5 offset:8192
  ds_read_b64_tr_b16 v[150:151], v5 offset:9216
  s_barrier
  s_waitcnt vmcnt(10) lgkmcnt(6)
  v_mfma_f32_32x32x16_bf16 v[208:223], v[136:139], v[180:183], v[208:223]
  s_add_u32 s93, s68, 4096
  buffer_load_dwordx4 v[176:179], v1, s[48:51], s93 offen offset:0 sc1
  ds_read_b64_tr_b16 v[152:153], v4 offset:10240
  s_waitcnt lgkmcnt(5)
  v_mfma_f32_32x32x16_bf16 v[224:239], v[140:143], v[180:183], v[224:239]
  ds_read_b64_tr_b16 v[154:155], v4 offset:11264
  ds_read_b64_tr_b16 v[156:157], v5 offset:10240
  ds_read_b64_tr_b16 v[158:159], v5 offset:11264
  s_waitcnt vmcnt(10) lgkmcnt(6)
  v_mfma_f32_32x32x16_bf16 v[208:223], v[144:147], v[184:187], v[208:223]
  buffer_load_dwordx4 v[180:183], v1, s[48:51], s93 offen offset:1024 sc1
  ds_read_b64_tr_b16 v[128:129], v4 offset:12288
  s_waitcnt lgkmcnt(5)
  v_mfma_f32_32x32x16_bf16 v[224:239], v[148:151], v[184:187], v[224:239]
  ds_read_b64_tr_b16 v[130:131], v4 offset:13312
  ds_read_b64_tr_b16 v[132:133], v5 offset:12288
  ds_read_b64_tr_b16 v[134:135], v5 offset:13312
  s_waitcnt vmcnt(10) lgkmcnt(6)
  v_mfma_f32_32x32x16_bf16 v[208:223], v[152:155], v[188:191], v[208:223]
  s_waitcnt lgkmcnt(4)
  v_mfma_f32_32x32x16_bf16 v[224:239], v[156:159], v[188:191], v[224:239]
  buffer_load_dwordx4 v[184:187], v1, s[48:51], s93 offen offset:2048 sc1
  s_waitcnt vmcnt(10) lgkmcnt(2)
  v_mfma_f32_32x32x16_bf16 v[208:223], v[128:131], v[192:195], v[208:223]
  s_waitcnt lgkmcnt(0)
  v_mfma_f32_32x32x16_bf16 v[224:239], v[132:135], v[192:195], v[224:239]
  buffer_load_dwordx4 v[188:191], v1, s[48:51], s93 offen offset:3072 sc1
  v_add_u32 v4, 98304, v4
  v_add_u32 v5, 98304, v5
  s_barrier
  ds_read_b64_tr_b16 v[136:137], v4 offset:0
  ds_read_b64_tr_b16 v[138:139], v4 offset:1024
  ds_read_b64_tr_b16 v[140:141], v5 offset:0
  ds_read_b64_tr_b16 v[142:143], v5 offset:1024
  ds_read_b64_tr_b16 v[144:145], v4 offset:2048
  ds_read_b64_tr_b16 v[146:147], v4 offset:3072
  ds_read_b64_tr_b16 v[148:149], v5 offset:2048
  ds_read_b64_tr_b16 v[150:151], v5 offset:3072
  s_waitcnt vmcnt(10) lgkmcnt(6)
  v_mfma_f32_32x32x16_bf16 v[208:223], v[136:139], v[196:199], v[208:223]
  s_add_u32 s93, s69, 4096
  buffer_load_dwordx4 v[192:195], v1, s[48:51], s93 offen offset:0 sc1
  ds_read_b64_tr_b16 v[152:153], v4 offset:4096
  s_waitcnt lgkmcnt(5)
  v_mfma_f32_32x32x16_bf16 v[224:239], v[140:143], v[196:199], v[224:239]
  ds_read_b64_tr_b16 v[154:155], v4 offset:5120
  ds_read_b64_tr_b16 v[156:157], v5 offset:4096
  ds_read_b64_tr_b16 v[158:159], v5 offset:5120
  s_waitcnt vmcnt(10) lgkmcnt(6)
  v_mfma_f32_32x32x16_bf16 v[208:223], v[144:147], v[200:203], v[208:223]
  buffer_load_dwordx4 v[196:199], v1, s[48:51], s93 offen offset:1024 sc1
  ds_read_b64_tr_b16 v[128:129], v4 offset:6144
  s_waitcnt lgkmcnt(5)
  v_mfma_f32_32x32x16_bf16 v[224:239], v[148:151], v[200:203], v[224:239]
  ds_read_b64_tr_b16 v[130:131], v4 offset:7168
  ds_read_b64_tr_b16 v[132:133], v5 offset:6144
  ds_read_b64_tr_b16 v[134:135], v5 offset:7168
  s_waitcnt vmcnt(10) lgkmcnt(6)
  v_mfma_f32_32x32x16_bf16 v[208:223], v[152:155], v[204:207], v[208:223]
  buffer_load_dwordx4 v[200:203], v1, s[48:51], s93 offen offset:2048 sc1
  ds_read_b64_tr_b16 v[136:137], v4 offset:8192
  s_waitcnt lgkmcnt(5)
  v_mfma_f32_32x32x16_bf16 v[224:239], v[156:159], v[204:207], v[224:239]
  ds_read_b64_tr_b16 v[138:139], v4 offset:9216
  ds_read_b64_tr_b16 v[140:141], v5 offset:8192
  ds_read_b64_tr_b16 v[142:143], v5 offset:9216
  s_waitcnt vmcnt(10) lgkmcnt(6)
  v_mfma_f32_32x32x16_bf16 v[208:223], v[128:131], v[160:163], v[208:223]
  buffer_load_dwordx4 v[204:207], v1, s[48:51], s93 offen offset:3072 sc1
  ds_read_b64_tr_b16 v[144:145], v4 offset:10240
  s_waitcnt lgkmcnt(5)
  v_mfma_f32_32x32x16_bf16 v[224:239], v[132:135], v[160:163], v[224:239]
  ds_read_b64_tr_b16 v[146:147], v4 offset:11264
  ds_read_b64_tr_b16 v[148:149], v5 offset:10240
  ds_read_b64_tr_b16 v[150:151], v5 offset:11264
  s_waitcnt vmcnt(10) lgkmcnt(6)
  v_mfma_f32_32x32x16_bf16 v[208:223], v[136:139], v[164:167], v[208:223]
  s_add_u32 s93, s70, 4096
  buffer_load_dwordx4 v[160:163], v1, s[48:51], s93 offen offset:0 sc1
  ds_read_b64_tr_b16 v[152:153], v4 offset:12288
  s_waitcnt lgkmcnt(5)
  v_mfma_f32_32x32x16_bf16 v[224:239], v[140:143], v[164:167], v[224:239]
  ds_read_b64_tr_b16 v[154:155], v4 offset:13312
  ds_read_b64_tr_b16 v[156:157], v5 offset:12288
  ds_read_b64_tr_b16 v[158:159], v5 offset:13312
  s_waitcnt vmcnt(10) lgkmcnt(6)
  v_mfma_f32_32x32x16_bf16 v[208:223], v[144:147], v[168:171], v[208:223]
  s_waitcnt lgkmcnt(4)
  v_mfma_f32_32x32x16_bf16 v[224:239], v[148:151], v[168:171], v[224:239]
  buffer_load_dwordx4 v[164:167], v1, s[48:51], s93 offen offset:1024 sc1
  s_waitcnt vmcnt(10) lgkmcnt(2)
  v_mfma_f32_32x32x16_bf16 v[208:223], v[152:155], v[172:175], v[208:223]
  s_waitcnt lgkmcnt(0)
  v_mfma_f32_32x32x16_bf16 v[224:239], v[156:159], v[172:175], v[224:239]
  buffer_load_dwordx4 v[168:171], v1, s[48:51], s93 offen offset:2048 sc1
  v_add_u32 v4, 4294901760, v4
  v_add_u32 v5, 4294901760, v5
  ds_read_b64_tr_b16 v[128:129], v4 offset:0
  ds_read_b64_tr_b16 v[130:131], v4 offset:1024
  ds_read_b64_tr_b16 v[132:133], v5 offset:0
  ds_read_b64_tr_b16 v[134:135], v5 offset:1024
  ds_read_b64_tr_b16 v[136:137], v4 offset:2048
  ds_read_b64_tr_b16 v[138:139], v4 offset:3072
  ds_read_b64_tr_b16 v[140:141], v5 offset:2048
  ds_read_b64_tr_b16 v[142:143], v5 offset:3072
  s_waitcnt vmcnt(10) lgkmcnt(6)
  v_mfma_f32_32x32x16_bf16 v[208:223], v[128:131], v[176:179], v[208:223]
  buffer_load_dwordx4 v[172:175], v1, s[48:51], s93 offen offset:3072 sc1
  ds_read_b64_tr_b16 v[144:145], v4 offset:4096
  s_waitcnt lgkmcnt(5)
  v_mfma_f32_32x32x16_bf16 v[224:239], v[132:135], v[176:179], v[224:239]
  ds_read_b64_tr_b16 v[146:147], v4 offset:5120
  ds_read_b64_tr_b16 v[148:149], v5 offset:4096
  ds_read_b64_tr_b16 v[150:151], v5 offset:5120
  s_waitcnt vmcnt(10) lgkmcnt(6)
  v_mfma_f32_32x32x16_bf16 v[208:223], v[136:139], v[180:183], v[208:223]
  s_add_u32 s93, s71, 4096
  buffer_load_dwordx4 v[176:179], v1, s[48:51], s93 offen offset:0 sc1
  ds_read_b64_tr_b16 v[152:153], v4 offset:6144
  s_waitcnt lgkmcnt(5)
  v_mfma_f32_32x32x16_bf16 v[224:239], v[140:143], v[180:183], v[224:239]
  ds_read_b64_tr_b16 v[154:155], v4 offset:7168
  ds_read_b64_tr_b16 v[156:157], v5 offset:6144
  ds_read_b64_tr_b16 v[158:159], v5 offset:7168
  s_waitcnt vmcnt(10) lgkmcnt(6)
  v_mfma_f32_32x32x16_bf16 v[208:223], v[144:147], v[184:187], v[208:223]
  buffer_load_dwordx4 v[180:183], v1, s[48:51], s93 offen offset:1024 sc1
  ds_read_b64_tr_b16 v[128:129], v4 offset:8192
  s_waitcnt lgkmcnt(5)
  v_mfma_f32_32x32x16_bf16 v[224:239], v[148:151], v[184:187], v[224:239]
  ds_read_b64_tr_b16 v[130:131], v4 offset:9216
  ds_read_b64_tr_b16 v[132:133], v5 offset:8192
  ds_read_b64_tr_b16 v[134:135], v5 offset:9216
  s_waitcnt vmcnt(10) lgkmcnt(6)
  v_mfma_f32_32x32x16_bf16 v[208:223], v[152:155], v[188:191], v[208:223]
  buffer_load_dwordx4 v[184:187], v1, s[48:51], s93 offen offset:2048 sc1
  ds_read_b64_tr_b16 v[136:137], v4 offset:10240
  s_waitcnt lgkmcnt(5)
  v_mfma_f32_32x32x16_bf16 v[224:239], v[156:159], v[188:191], v[224:239]
  ds_read_b64_tr_b16 v[138:139], v4 offset:11264
  ds_read_b64_tr_b16 v[140:141], v5 offset:10240
  ds_read_b64_tr_b16 v[142:143], v5 offset:11264
  s_waitcnt vmcnt(10) lgkmcnt(6)
  v_mfma_f32_32x32x16_bf16 v[208:223], v[128:131], v[192:195], v[208:223]
  buffer_load_dwordx4 v[188:191], v1, s[48:51], s93 offen offset:3072 sc1
  ds_read_b64_tr_b16 v[144:145], v4 offset:12288
  s_waitcnt lgkmcnt(5)
  v_mfma_f32_32x32x16_bf16 v[224:239], v[132:135], v[192:195], v[224:239]
  ds_read_b64_tr_b16 v[146:147], v4 offset:13312
  ds_read_b64_tr_b16 v[148:149], v5 offset:12288
  ds_read_b64_tr_b16 v[150:151], v5 offset:13312
  s_waitcnt vmcnt(10) lgkmcnt(6)
  v_mfma_f32_32x32x16_bf16 v[208:223], v[136:139], v[196:199], v[208:223]
  s_add_u32 s93, s72, 4096
  s_waitcnt lgkmcnt(4)
  v_mfma_f32_32x32x16_bf16 v[224:239], v[140:143], v[196:199], v[224:239]
  buffer_load_dwordx4 v[192:195], v1, s[48:51], s93 offen offset:0 sc1
  s_waitcnt vmcnt(10) lgkmcnt(2)
  v_mfma_f32_32x32x16_bf16 v[208:223], v[144:147], v[200:203], v[208:223]
  s_waitcnt lgkmcnt(0)
  v_mfma_f32_32x32x16_bf16 v[224:239], v[148:151], v[200:203], v[224:239]
  buffer_load_dwordx4 v[196:199], v1, s[48:51], s93 offen offset:1024 sc1
  v_add_u32 v4, 98304, v4
  v_add_u32 v5, 98304, v5
  ds_read_b64_tr_b16 v[152:153], v4 offset:0
  ds_read_b64_tr_b16 v[154:155], v4 offset:1024
  ds_read_b64_tr_b16 v[156:157], v5 offset:0
  ds_read_b64_tr_b16 v[158:159], v5 offset:1024
  ds_read_b64_tr_b16 v[128:129], v4 offset:2048
  ds_read_b64_tr_b16 v[130:131], v4 offset:3072
  ds_read_b64_tr_b16 v[132:133], v5 offset:2048
  ds_read_b64_tr_b16 v[134:135], v5 offset:3072
  s_waitcnt vmcnt(10) lgkmcnt(6)
  v_mfma_f32_32x32x16_bf16 v[208:223], v[152:155], v[204:207], v[208:223]
  buffer_load_dwordx4 v[200:203], v1, s[48:51], s93 offen offset:2048 sc1
  ds_read_b64_tr_b16 v[136:137], v4 offset:4096
  s_waitcnt lgkmcnt(5)
  v_mfma_f32_32x32x16_bf16 v[224:239], v[156:159], v[204:207], v[224:239]
  ds_read_b64_tr_b16 v[138:139], v4 offset:5120
  ds_read_b64_tr_b16 v[140:141], v5 offset:4096
  ds_read_b64_tr_b16 v[142:143], v5 offset:5120
  s_waitcnt vmcnt(10) lgkmcnt(6)
  v_mfma_f32_32x32x16_bf16 v[208:223], v[128:131], v[160:163], v[208:223]
  buffer_load_dwordx4 v[204:207], v1, s[48:51], s93 offen offset:3072 sc1
  ds_read_b64_tr_b16 v[144:145], v4 offset:6144
  s_waitcnt lgkmcnt(5)
  v_mfma_f32_32x32x16_bf16 v[224:239], v[132:135], v[160:163], v[224:239]
  ds_read_b64_tr_b16 v[146:147], v4 offset:7168
  ds_read_b64_tr_b16 v[148:149], v5 offset:6144
  ds_read_b64_tr_b16 v[150:151], v5 offset:7168
  s_waitcnt vmcnt(10) lgkmcnt(6)
  v_mfma_f32_32x32x16_bf16 v[208:223], v[136:139], v[164:167], v[208:223]
  s_add_u32 s93, s73, 4096
  buffer_load_dwordx4 v[160:163], v1, s[48:51], s93 offen offset:0 sc1
  ds_read_b64_tr_b16 v[152:153], v4 offset:8192
  s_waitcnt lgkmcnt(5)
  v_mfma_f32_32x32x16_bf16 v[224:239], v[140:143], v[164:167], v[224:239]
  ds_read_b64_tr_b16 v[154:155], v4 offset:9216
  ds_read_b64_tr_b16 v[156:157], v5 offset:8192
  ds_read_b64_tr_b16 v[158:159], v5 offset:9216
  s_waitcnt vmcnt(10) lgkmcnt(6)
  v_mfma_f32_32x32x16_bf16 v[208:223], v[144:147], v[168:171], v[208:223]
  buffer_load_dwordx4 v[164:167], v1, s[48:51], s93 offen offset:1024 sc1
  ds_read_b64_tr_b16 v[128:129], v4 offset:10240
  s_waitcnt lgkmcnt(5)
  v_mfma_f32_32x32x16_bf16 v[224:239], v[148:151], v[168:171], v[224:239]
  ds_read_b64_tr_b16 v[130:131], v4 offset:11264
  ds_read_b64_tr_b16 v[132:133], v5 offset:10240
  ds_read_b64_tr_b16 v[134:135], v5 offset:11264
  s_waitcnt vmcnt(10) lgkmcnt(6)
  v_mfma_f32_32x32x16_bf16 v[208:223], v[152:155], v[172:175], v[208:223]
  buffer_load_dwordx4 v[168:171], v1, s[48:51], s93 offen offset:2048 sc1
  ds_read_b64_tr_b16 v[136:137], v4 offset:12288
  s_waitcnt lgkmcnt(5)
  v_mfma_f32_32x32x16_bf16 v[224:239], v[156:159], v[172:175], v[224:239]
  ds_read_b64_tr_b16 v[138:139], v4 offset:13312
  ds_read_b64_tr_b16 v[140:141], v5 offset:12288
  ds_read_b64_tr_b16 v[142:143], v5 offset:13312
  s_waitcnt vmcnt(10) lgkmcnt(6)
  v_mfma_f32_32x32x16_bf16 v[208:223], v[128:131], v[176:179], v[208:223]
  s_waitcnt lgkmcnt(4)
  v_mfma_f32_32x32x16_bf16 v[224:239], v[132:135], v[176:179], v[224:239]
  buffer_load_dwordx4 v[172:175], v1, s[48:51], s93 offen offset:3072 sc1
  s_waitcnt vmcnt(10) lgkmcnt(2)
  v_mfma_f32_32x32x16_bf16 v[208:223], v[136:139], v[180:183], v[208:223]
  s_add_u32 s93, s74, 4096
  s_waitcnt lgkmcnt(0)
  v_mfma_f32_32x32x16_bf16 v[224:239], v[140:143], v[180:183], v[224:239]
  buffer_load_dwordx4 v[176:179], v1, s[48:51], s93 offen offset:0 sc1
  v_add_u32 v4, 4294901760, v4
  v_add_u32 v5, 4294901760, v5
  ds_read_b64_tr_b16 v[144:145], v4 offset:0
  ds_read_b64_tr_b16 v[146:147], v4 offset:1024
  ds_read_b64_tr_b16 v[148:149], v5 offset:0
  ds_read_b64_tr_b16 v[150:151], v5 offset:1024
  ds_read_b64_tr_b16 v[152:153], v4 offset:2048
  ds_read_b64_tr_b16 v[154:155], v4 offset:3072
  ds_read_b64_tr_b16 v[156:157], v5 offset:2048
  ds_read_b64_tr_b16 v[158:159], v5 offset:3072
  s_waitcnt vmcnt(10) lgkmcnt(6)
  v_mfma_f32_32x32x16_bf16 v[208:223], v[144:147], v[184:187], v[208:223]
  buffer_load_dwordx4 v[180:183], v1, s[48:51], s93 offen offset:1024 sc1
  ds_read_b64_tr_b16 v[128:129], v4 offset:4096
  s_waitcnt lgkmcnt(5)
  v_mfma_f32_32x32x16_bf16 v[224:239], v[148:151], v[184:187], v[224:239]
  ds_read_b64_tr_b16 v[130:131], v4 offset:5120
  ds_read_b64_tr_b16 v[132:133], v5 offset:4096
  ds_read_b64_tr_b16 v[134:135], v5 offset:5120
  s_waitcnt vmcnt(10) lgkmcnt(6)
  v_mfma_f32_32x32x16_bf16 v[208:223], v[152:155], v[188:191], v[208:223]
  buffer_load_dwordx4 v[184:187], v1, s[48:51], s93 offen offset:2048 sc1
  ds_read_b64_tr_b16 v[136:137], v4 offset:6144
  s_waitcnt lgkmcnt(5)
  v_mfma_f32_32x32x16_bf16 v[224:239], v[156:159], v[188:191], v[224:239]
  ds_read_b64_tr_b16 v[138:139], v4 offset:7168
  ds_read_b64_tr_b16 v[140:141], v5 offset:6144
  ds_read_b64_tr_b16 v[142:143], v5 offset:7168
  s_waitcnt vmcnt(10) lgkmcnt(6)
  v_mfma_f32_32x32x16_bf16 v[208:223], v[128:131], v[192:195], v[208:223]
  buffer_load_dwordx4 v[188:191], v1, s[48:51], s93 offen offset:3072 sc1
  ds_read_b64_tr_b16 v[144:145], v4 offset:8192
  s_waitcnt lgkmcnt(5)
  v_mfma_f32_32x32x16_bf16 v[224:239], v[132:135], v[192:195], v[224:239]
  ds_read_b64_tr_b16 v[146:147], v4 offset:9216
  ds_read_b64_tr_b16 v[148:149], v5 offset:8192
  ds_read_b64_tr_b16 v[150:151], v5 offset:9216
  s_waitcnt vmcnt(10) lgkmcnt(6)
  v_mfma_f32_32x32x16_bf16 v[208:223], v[136:139], v[196:199], v[208:223]
  ds_read_b64_tr_b16 v[152:153], v4 offset:10240
  ds_read_b64_tr_b16 v[154:155], v4 offset:11264
  s_waitcnt lgkmcnt(6)
  v_mfma_f32_32x32x16_bf16 v[224:239], v[140:143], v[196:199], v[224:239]
  ds_read_b64_tr_b16 v[156:157], v5 offset:10240
  ds_read_b64_tr_b16 v[158:159], v5 offset:11264
  s_waitcnt vmcnt(9) lgkmcnt(6)
  v_mfma_f32_32x32x16_bf16 v[208:223], v[144:147], v[200:203], v[208:223]
  ds_read_b64_tr_b16 v[128:129], v4 offset:12288
  ds_read_b64_tr_b16 v[130:131], v4 offset:13312
  s_waitcnt lgkmcnt(6)
  v_mfma_f32_32x32x16_bf16 v[224:239], v[148:151], v[200:203], v[224:239]
  ds_read_b64_tr_b16 v[132:133], v5 offset:12288
  ds_read_b64_tr_b16 v[134:135], v5 offset:13312
  s_waitcnt vmcnt(8) lgkmcnt(6)
  v_mfma_f32_32x32x16_bf16 v[208:223], v[152:155], v[204:207], v[208:223]
  s_waitcnt lgkmcnt(4)
  v_mfma_f32_32x32x16_bf16 v[224:239], v[156:159], v[204:207], v[224:239]
  s_waitcnt vmcnt(7) lgkmcnt(2)
  v_mfma_f32_32x32x16_bf16 v[208:223], v[128:131], v[160:163], v[208:223]
  s_waitcnt lgkmcnt(0)
  v_mfma_f32_32x32x16_bf16 v[224:239], v[132:135], v[160:163], v[224:239]
  v_add_u32 v4, 4294901760, v4
  v_add_u32 v5, 4294901760, v5
  s_barrier
  ds_read_b64_tr_b16 v[136:137], v4 offset:0
  ds_read_b64_tr_b16 v[138:139], v4 offset:1024
  ds_read_b64_tr_b16 v[140:141], v5 offset:0
  ds_read_b64_tr_b16 v[142:143], v5 offset:1024
  ds_read_b64_tr_b16 v[144:145], v4 offset:2048
  ds_read_b64_tr_b16 v[146:147], v4 offset:3072
  ds_read_b64_tr_b16 v[148:149], v5 offset:2048
  ds_read_b64_tr_b16 v[150:151], v5 offset:3072
  s_waitcnt vmcnt(6) lgkmcnt(6)
  v_mfma_f32_32x32x16_bf16 v[208:223], v[136:139], v[164:167], v[208:223]
  ds_read_b64_tr_b16 v[152:153], v4 offset:4096
  ds_read_b64_tr_b16 v[154:155], v4 offset:5120
  s_waitcnt lgkmcnt(6)
  v_mfma_f32_32x32x16_bf16 v[224:239], v[140:143], v[164:167], v[224:239]
  ds_read_b64_tr_b16 v[156:157], v5 offset:4096
  ds_read_b64_tr_b16 v[158:159], v5 offset:5120
  s_waitcnt vmcnt(5) lgkmcnt(6)
  v_mfma_f32_32x32x16_bf16 v[208:223], v[144:147], v[168:171], v[208:223]
  ds_read_b64_tr_b16 v[128:129], v4 offset:6144
  ds_read_b64_tr_b16 v[130:131], v4 offset:7168
  s_waitcnt lgkmcnt(6)
  v_mfma_f32_32x32x16_bf16 v[224:239], v[148:151], v[168:171], v[224:239]
  ds_read_b64_tr_b16 v[132:133], v5 offset:6144
  ds_read_b64_tr_b16 v[134:135], v5 offset:7168
  s_waitcnt vmcnt(4) lgkmcnt(6)
  v_mfma_f32_32x32x16_bf16 v[208:223], v[152:155], v[172:175], v[208:223]
  ds_read_b64_tr_b16 v[136:137], v4 offset:8192
  ds_read_b64_tr_b16 v[138:139], v4 offset:9216
  s_waitcnt lgkmcnt(6)
  v_mfma_f32_32x32x16_bf16 v[224:239], v[156:159], v[172:175], v[224:239]
  ds_read_b64_tr_b16 v[140:141], v5 offset:8192
  ds_read_b64_tr_b16 v[142:143], v5 offset:9216
  s_waitcnt vmcnt(3) lgkmcnt(6)
  v_mfma_f32_32x32x16_bf16 v[208:223], v[128:131], v[176:179], v[208:223]
  ds_read_b64_tr_b16 v[144:145], v4 offset:10240
  ds_read_b64_tr_b16 v[146:147], v4 offset:11264
  s_waitcnt lgkmcnt(6)
  v_mfma_f32_32x32x16_bf16 v[224:239], v[132:135], v[176:179], v[224:239]
  ds_read_b64_tr_b16 v[148:149], v5 offset:10240
  ds_read_b64_tr_b16 v[150:151], v5 offset:11264
  s_waitcnt vmcnt(2) lgkmcnt(6)
  v_mfma_f32_32x32x16_bf16 v[208:223], v[136:139], v[180:183], v[208:223]
  ds_read_b64_tr_b16 v[152:153], v4 offset:12288
  ds_read_b64_tr_b16 v[154:155], v4 offset:13312
  s_waitcnt lgkmcnt(6)
  v_mfma_f32_32x32x16_bf16 v[224:239], v[140:143], v[180:183], v[224:239]
  ds_read_b64_tr_b16 v[156:157], v5 offset:12288
  ds_read_b64_tr_b16 v[158:159], v5 offset:13312
  s_waitcnt vmcnt(1) lgkmcnt(6)
  v_mfma_f32_32x32x16_bf16 v[208:223], v[144:147], v[184:187], v[208:223]
  s_waitcnt lgkmcnt(4)
  v_mfma_f32_32x32x16_bf16 v[224:239], v[148:151], v[184:187], v[224:239]
  s_waitcnt vmcnt(0) lgkmcnt(2)
  v_mfma_f32_32x32x16_bf16 v[208:223], v[152:155], v[188:191], v[208:223]
  s_waitcnt lgkmcnt(0)
  v_mfma_f32_32x32x16_bf16 v[224:239], v[156:159], v[188:191], v[224:239]
  s_lshl_b32 s62, s56, 12
  s_add_u32 s62, s62, 98304
  v_add_u32 v2, s62, v1
  v_xor_b32 v3, 4096, v2
  v_lshlrev_b32 v48, 16, v240
  v_and_b32 v49, 0xffff0000, v240
  v_lshlrev_b32 v50, 16, v241
  v_and_b32 v51, 0xffff0000, v241
  v_lshlrev_b32 v52, 16, v242
  v_and_b32 v53, 0xffff0000, v242
  v_lshlrev_b32 v54, 16, v243
  v_and_b32 v55, 0xffff0000, v243
  v_lshlrev_b32 v56, 16, v244
  v_and_b32 v57, 0xffff0000, v244
  v_lshlrev_b32 v58, 16, v245
  v_and_b32 v59, 0xffff0000, v245
  v_lshlrev_b32 v60, 16, v246
  v_and_b32 v61, 0xffff0000, v246
  v_lshlrev_b32 v62, 16, v247
  v_and_b32 v63, 0xffff0000, v247
  ds_write_b128 v2, v[224:227] offset:0
  ds_write_b128 v2, v[228:231] offset:1024
  ds_write_b128 v2, v[232:235] offset:2048
  ds_write_b128 v2, v[236:239] offset:3072
  v_lshlrev_b32 v64, 16, v248
  v_and_b32 v65, 0xffff0000, v248
  v_lshlrev_b32 v66, 16, v249
  v_and_b32 v67, 0xffff0000, v249
  v_lshlrev_b32 v68, 16, v250
  v_and_b32 v69, 0xffff0000, v250
  v_lshlrev_b32 v70, 16, v251
  v_and_b32 v71, 0xffff0000, v251
  v_lshlrev_b32 v72, 16, v252
  v_and_b32 v73, 0xffff0000, v252
  v_lshlrev_b32 v74, 16, v253
  v_and_b32 v75, 0xffff0000, v253
  v_lshlrev_b32 v76, 16, v254
  v_and_b32 v77, 0xffff0000, v254
  v_lshlrev_b32 v78, 16, v255
  v_and_b32 v79, 0xffff0000, v255
  v_add_f32 v48, v48, v64
  v_add_f32 v49, v49, v65
  v_add_f32 v50, v50, v66
  v_add_f32 v51, v51, v67
  v_add_f32 v52, v52, v68
  v_add_f32 v53, v53, v69
  v_add_f32 v54, v54, v70
  v_add_f32 v55, v55, v71
  v_add_f32 v56, v56, v72
  v_add_f32 v57, v57, v73
  v_add_f32 v58, v58, v74
  v_add_f32 v59, v59, v75
  v_add_f32 v60, v60, v76
  v_add_f32 v61, v61, v77
  v_add_f32 v62, v62, v78
  v_add_f32 v63, v63, v79
  v_add_f32 v208, v208, v48
  v_add_f32 v209, v209, v49
  v_add_f32 v210, v210, v50
  v_add_f32 v211, v211, v51
  v_add_f32 v212, v212, v52
  v_add_f32 v213, v213, v53
  v_add_f32 v214, v214, v54
  v_add_f32 v215, v215, v55
  v_add_f32 v216, v216, v56
  v_add_f32 v217, v217, v57
  v_add_f32 v218, v218, v58
  v_add_f32 v219, v219, v59
  v_add_f32 v220, v220, v60
  v_add_f32 v221, v221, v61
  v_add_f32 v222, v222, v62
  v_add_f32 v223, v223, v63
  s_mov_b32 s52, s20
  s_mov_b32 s53, s21
  s_mov_b32 s54, 2097152
  s_mov_b32 s55, 0x20000
  v_and_b32 v12, 15, v0
  v_lshlrev_b32 v12, 1, v12
  v_bfe_u32 v13, v0, 4, 1
  v_add_u32 v12, v12, v13
  s_lshl_b32 s62, s59, 1
  s_add_u32 s62, s62, s90
  s_lshl_b32 s62, s62, 5
  v_add_u32 v12, s62, v12
  v_lshlrev_b32 v12, 10, v12
  v_lshrrev_b32 v13, 5, v0
  v_lshl_add_u32 v12, v13, 4, v12
  s_lshl_b32 s92, s60, 7
  s_lshl_b32 s63, s91, 6
  s_add_u32 s92, s92, s63
  s_waitcnt lgkmcnt(0)
  s_barrier
  ds_read_b128 v[32:35], v3 offset:0
  ds_read_b128 v[36:39], v3 offset:1024
  ds_read_b128 v[40:43], v3 offset:2048
  ds_read_b128 v[44:47], v3 offset:3072
  s_waitcnt lgkmcnt(3)
  v_add_f32 v208, v208, v32
  v_add_f32 v209, v209, v33
  v_add_f32 v210, v210, v34
  v_add_f32 v211, v211, v35
  s_waitcnt lgkmcnt(2)
  v_add_f32 v212, v212, v36
  v_add_f32 v213, v213, v37
  v_add_f32 v214, v214, v38
  v_add_f32 v215, v215, v39
  s_waitcnt lgkmcnt(1)
  v_add_f32 v216, v216, v40
  v_add_f32 v217, v217, v41
  v_add_f32 v218, v218, v42
  v_add_f32 v219, v219, v43
  s_waitcnt lgkmcnt(0)
  v_add_f32 v220, v220, v44
  v_add_f32 v221, v221, v45
  v_add_f32 v222, v222, v46
  v_add_f32 v223, v223, v47
  v_cvt_pk_bf16_f32 v64, v208, v209
  v_cvt_pk_bf16_f32 v65, v210, v211
  v_cvt_pk_bf16_f32 v66, v212, v213
  v_cvt_pk_bf16_f32 v67, v214, v215
  v_cvt_pk_bf16_f32 v68, v216, v217
  v_cvt_pk_bf16_f32 v69, v218, v219
  v_cvt_pk_bf16_f32 v70, v220, v221
  v_cvt_pk_bf16_f32 v71, v222, v223
  v_permlane32_swap_b32 v64, v66
  v_permlane32_swap_b32 v65, v67
  v_permlane32_swap_b32 v68, v70
  v_permlane32_swap_b32 v69, v71
  v_and_b32 v2, 31, v0
  s_lshl_b32 s62, s90, 5
  v_add_u32 v2, s62, v2
  v_lshrrev_b32 v3, 5, v0
  s_lshl_b32 s62, s91, 2
  v_add_u32 v3, s62, v3
  v_and_b32 v13, 7, v2
  v_xor_b32 v3, v3, v13
  v_lshlrev_b32 v3, 4, v3
  v_lshl_add_u32 v2, v2, 7, v3
  v_add_u32 v2, 0, v2
  v_xor_b32 v3, 32, v2
  ds_write_b128 v2, v[64:67]
  ds_write_b128 v3, v[68:71]
  v_lshrrev_b32 v12, 3, v0
  v_and_b32 v13, 7, v0
  v_xor_b32 v14, v13, v12
  v_lshlrev_b32 v14, 4, v14
  v_lshl_add_u32 v14, v12, 7, v14
  s_lshl_b32 s62, s56, 11
  s_add_u32 s62, s62, 0
  v_add_u32 v14, s62, v14
  v_lshlrev_b32 v12, 11, v12
  v_lshl_add_u32 v12, v13, 4, v12
  s_lshl_b32 s62, s59, 6
  s_lshl_b32 s63, s90, 5
  s_add_u32 s62, s62, s63
  s_add_u32 s62, s62, s91
  s_lshl_b32 s62, s62, 10
  s_lshl_b32 s63, s60, 7
  s_add_u32 s92, s62, s63
  s_add_u32 s93, s92, 16384
  s_waitcnt lgkmcnt(0)
  s_barrier
  ds_read_b128 v[64:67], v14
  ds_read_b128 v[68:71], v14 offset:1024
  s_waitcnt lgkmcnt(1)
  buffer_store_dwordx4 v[64:67], v12, s[52:55], s92 offen nt
  s_waitcnt lgkmcnt(0)
  buffer_store_dwordx4 v[68:71], v12, s[52:55], s93 offen nt
  s_branch L_END
L_END:
  s_endpgm
.section .rodata,"a"
.p2align 6
.amdhsa_kernel sequential_preLN__sliding_local_dilated__dense_activation_gelu__prompt_kernel
  .amdhsa_next_free_vgpr 256
  .amdhsa_next_free_sgpr 102
  .amdhsa_accum_offset 256
  .amdhsa_group_segment_fixed_size 0
  .amdhsa_kernarg_size 88
  .amdhsa_user_sgpr_count 2
  .amdhsa_user_sgpr_kernarg_segment_ptr 1
  .amdhsa_system_sgpr_workgroup_id_x 1
.end_amdhsa_kernel
```
